```python
import torch

def _softmax(x, axis=-1):
    return torch.softmax(x, dim=axis)
def _gelu(x):
    return torch.nn.functional.gelu(x, approximate="tanh")
def _silu(x):
    return torch.nn.functional.silu(x)
def _sigmoid(x):
    return torch.sigmoid(x)
def _layernorm(x, axis=-1, eps=1e-5):
    m = x.mean(dim=axis, keepdim=True)
    v = x.var(dim=axis, keepdim=True, unbiased=False)
    return (x - m) / torch.sqrt(v + eps)
def _scatter_add(tgt, idx, src, axis=0):
    return tgt.clone().index_add_(axis, idx, src)
def _segment_sum(src, seg, n):
    out = torch.zeros((n,) + src.shape[1:], dtype=src.dtype)
    return out.index_add_(0, seg, src)
def _pad(x, pw):
    flat = tuple(v for pair in reversed(pw) for v in pair)
    return torch.nn.functional.pad(x, flat)

kernel_name = 'sequential_preLN__sliding_block_cached__glu_gated_swiglu__decode'

def setup_inputs():

    _w = (lambda a: (lambda t: t.to(torch.bfloat16) if t.is_floating_point() else t)(torch.as_tensor(a)))
    def _A_setup():
        B, Sq, D = 4, 1, 640
        Hq, Hkv, Sk, Dh = 32, 32, 8192, 128
        assert Hq % Hkv == 0, (Hq, Hkv)
        return {
            "x": _w((lambda *s: torch.randn(*s, dtype=torch.bfloat16) * 0.05)(B, Sq, D)),
            "k_cache": _w((lambda *s: torch.randn(*s, dtype=torch.bfloat16) * 1.6)(B, Hkv, Sk, Dh)),
            "v_cache": _w((lambda *s: torch.randn(*s, dtype=torch.bfloat16) * 0.8)(B, Hkv, Sk, Dh)),
            "wq": _w((lambda *s: torch.randn(*s, dtype=torch.bfloat16) * 1.6)(D, Hq * Dh) * (D ** -0.5)),
            "wo": _w((lambda *s: torch.randn(*s, dtype=torch.bfloat16) * 0.8)(Hq * Dh, D) * ((Hq * Dh) ** -0.5)),
        }
    _A_in = _A_setup()

    def _B_setup():
        B, S, D, F = 4, 1, 640, 1728
        return {
            "x": _w((lambda *s: torch.randn(*s, dtype=torch.bfloat16) * 0.05)(B, S, D)),
            "w1": _w((lambda *s: torch.randn(*s, dtype=torch.bfloat16) * 0.4)(D, F) * (2.0 / D) ** 0.5),
            "w3": _w((lambda *s: torch.randn(*s, dtype=torch.bfloat16) * 0.4)(D, F) * (2.0 / D) ** 0.5),
            "w2": _w((lambda *s: torch.randn(*s, dtype=torch.bfloat16) * 0.4)(F, D) * (2.0 / F) ** 0.5),
        }
    _B_in = _B_setup()

    return {
        "A_x": _A_in["x"],
        "A_k_cache": _A_in["k_cache"],
        "A_v_cache": _A_in["v_cache"],
        "A_wq": _A_in["wq"],
        "A_wo": _A_in["wo"],
        "B_x": _B_in["x"],
        "B_w1": _B_in["w1"],
        "B_w3": _B_in["w3"],
        "B_w2": _B_in["w2"],
    }

def reference(A_x, A_k_cache, A_v_cache, A_wq, A_wo, B_x, B_w1, B_w3, B_w2):
    def _A_ref(x, k_cache, v_cache, wq, wo):
        B, Sq, D = x.shape
        Hq, Dh = 32, 128
        Hkv, Sk = k_cache.shape[1], k_cache.shape[2]
        W = min(4096, max(256, Sk // 4))
        rep = Hq // Hkv
        q = (lambda x, *d: x.permute(*d))((x @ wq).reshape(B, Sq, Hq, Dh), 0, 2, 1, 3)
        k = (lambda x, n, axis: torch.repeat_interleave(x, n, dim=axis))(k_cache[:, :, Sk - W:, :], rep, axis=1)
        v = (lambda x, n, axis: torch.repeat_interleave(x, n, dim=axis))(v_cache[:, :, Sk - W:, :], rep, axis=1)
        scores = torch.einsum("bhqd,bhkd->bhqk", q, k) * (Dh ** -0.5)
        p = _softmax(scores, axis=-1)
        o = torch.einsum("bhqk,bhkd->bhqd", p, v)
        return (lambda x, *d: x.permute(*d))(o, 0, 2, 1, 3).reshape(B, Sq, Hq * Dh) @ wo

    def _B_ref(x, w1, w3, w2):
        gate = torch.einsum("bsd,df->bsf", x, w1)
        up = torch.einsum("bsd,df->bsf", x, w3)
        h = _silu(gate) * up
        out = torch.einsum("bsf,fd->bsd", h, w2)
        return out

    x = A_x
    h = x + _A_ref(_layernorm(x, axis=-1), A_k_cache, A_v_cache, A_wq, A_wo)
    h2 = h + _B_ref(_layernorm(h, axis=-1), B_w1, B_w3, B_w2)
    return h2
```

```asm
; @launch grid=(256,1,1) block=(256,1,1) lds=61440
.amdgcn_target "amdgcn-amd-amdhsa--gfx950"
.text
.globl sequential_preLN__sliding_block_cached__glu_gated_swiglu__decode_kernel
.p2align 8
.type sequential_preLN__sliding_block_cached__glu_gated_swiglu__decode_kernel,@function
sequential_preLN__sliding_block_cached__glu_gated_swiglu__decode_kernel:
    s_cmp_ge_u32 s2, 256
    s_cbranch_scc1 L_end
    s_load_dwordx16 s[16:31], s[0:1], 0
    s_load_dwordx8 s[32:39], s[0:1], 64
    v_lshrrev_b32 v40, 6, v0
    v_and_b32 v1, 63, v0
    v_readfirstlane_b32 s3, v40
    v_and_b32 v2, 15, v0
    v_lshrrev_b32 v3, 4, v1
    s_and_b32 s88, s2, 7
    s_lshr_b32 s89, s2, 6
    s_lshl_b32 s89, s89, 3
    s_add_u32 s8, s88, s89
    s_bfe_u32 s9, s2, 0x20004
    s_bfe_u32 s10, s2, 0x10003
    s_lshl_b32 s11, s9, 5
    s_add_u32 s11, s11, s8
    s_lshl_b32 s4, s11, 21
    s_lshl_b32 s88, s10, 14
    s_add_u32 s4, s4, s88
    s_lshl_b32 s88, s3, 12
    s_add_u32 s4, s4, s88
    s_add_u32 s4, s4, 0x180000
    s_mov_b32 s5, s4
    s_bfe_u32 s89, s2, 0x30003
    s_lshl_b32 s88, s89, 2
    s_add_u32 s88, s88, s3
    s_mul_i32 s6, s88, 163840
    s_lshl_b32 s88, s8, 8
    s_add_u32 s6, s6, s88
    s_mul_i32 s90, s3, 1280
    s_mul_i32 s91, s89, 160
    s_add_u32 s91, s91, s90
    v_lshrrev_b32 v243, 2, v2
    v_and_b32 v41, 2, v2
    v_lshl_add_u32 v40, v41, 1, v243
    v_lshlrev_b32 v4, 8, v40
    v_lshl_add_u32 v4, v3, 5, v4
    v_and_b32 v41, 1, v2
    v_lshl_add_u32 v4, v41, 4, v4
    v_lshlrev_b32 v5, 4, v1
    v_lshlrev_b32 v6, 13, v3
    v_lshl_add_u32 v6, v2, 4, v6
    v_lshlrev_b32 v42, 2, v1
    s_mov_b32 s42, 0x10000000
    s_mov_b32 s43, 0x00020000
    s_mov_b32 s58, 5120
    s_mov_b32 s59, 0x00020000
    s_mov_b32 s50, 5242880
    s_mov_b32 s51, 0x00020000
    s_waitcnt lgkmcnt(0)
    s_mov_b64 s[56:57], s[16:17]
    s_mov_b64 s[40:41], s[18:19]
    s_mov_b64 s[48:49], s[22:23]
    buffer_load_dwordx4 v[124:127], v4, s[40:43], s4 offen offset:0 nt
    buffer_load_dwordx4 v[120:123], v4, s[40:43], s4 offen offset:128 nt
    buffer_load_dwordx4 v[116:119], v4, s[40:43], s4 offen offset:2048 nt
    buffer_load_dwordx4 v[112:115], v4, s[40:43], s4 offen offset:2176 nt
    s_add_u32 s4, s4, 0x8000
    buffer_load_dword v208, v42, s[56:59], s90 offen offset:0
    buffer_load_dword v209, v42, s[56:59], s90 offen offset:256
    buffer_load_dword v210, v42, s[56:59], s90 offen offset:512
    buffer_load_dword v211, v42, s[56:59], s90 offen offset:768
    buffer_load_dword v212, v42, s[56:59], s90 offen offset:1024
    buffer_load_dword v213, v42, s[56:59], s91 offen
    buffer_load_dwordx4 v[64:67], v6, s[48:51], s6 offen nt
    s_add_u32 s6, s6, 0x8000
    buffer_load_dwordx4 v[68:71], v6, s[48:51], s6 offen nt
    s_add_u32 s6, s6, 0x8000
    buffer_load_dwordx4 v[72:75], v6, s[48:51], s6 offen nt
    s_add_u32 s6, s6, 0x8000
    buffer_load_dwordx4 v[76:79], v6, s[48:51], s6 offen nt
    s_add_u32 s6, s6, 0x8000
    buffer_load_dwordx4 v[80:83], v6, s[48:51], s6 offen nt
    s_add_u32 s6, s6, 0x8000
    buffer_load_dwordx4 v[108:111], v4, s[40:43], s4 offen offset:0 nt
    s_mov_b64 s[44:45], s[20:21]
    s_mov_b32 s46, 268435456
    s_mov_b32 s47, 0x00020000
    s_mov_b64 s[52:53], s[24:25]
    s_mov_b32 s54, 5242880
    s_mov_b32 s55, 0x00020000
    s_mov_b64 s[80:81], s[38:39]
    s_mov_b32 s82, 1955840
    s_mov_b32 s83, 0x00020000
    s_mov_b64 s[76:77], s[36:37]
    s_mov_b32 s78, 256
    s_mov_b32 s79, 0x00020000
    s_mov_b64 s[72:73], s[34:35]
    s_mov_b32 s74, 5120
    s_mov_b32 s75, 0x00020000
    s_mov_b64 s[60:61], s[28:29]
    s_mov_b64 s[64:65], s[30:31]
    s_lshr_b32 s31, s2, 3
    s_lshl_b32 s88, s8, 2
    s_add_u32 s89, s88, s3
    s_mul_i32 s7, s89, 40960
    v_mul_u32_u24 v7, 1280, v3
    v_lshl_add_u32 v7, v2, 4, v7
    v_add_u32 v250, 5120, v7
    s_lshl_b32 s89, s89, 3
    s_bfe_u32 s90, s2, 0x30003
    s_add_u32 s89, s89, s90
    s_lshl_b32 s22, s89, 9
    s_add_u32 s89, s88, s9
    s_lshl_b32 s89, s89, 2
    s_add_u32 s89, s89, s3
    s_lshl_b32 s23, s89, 10
    s_mov_b32 s96, 0x00010001
    s_mov_b32 s97, 0x00010001
    v_and_b32 v40, 1, v2
    v_lshlrev_b32 v40, 4, v40
    v_mov_b32 v41, 0xffff
    v_lshlrev_b32 v235, v40, v41
    v_bfe_u32 v40, v2, 1, 2
    v_cmp_eq_u32 vcc, 0, v40
    v_mov_b32 v36, -1
    s_nop 0
    v_cndmask_b32 v8, 0, v235, vcc
    v_cmp_eq_u32 vcc, 1, v40
    v_mov_b32 v37, -1
    s_nop 0
    v_cndmask_b32 v9, 0, v235, vcc
    v_cmp_eq_u32 vcc, 2, v40
    v_mov_b32 v38, -1
    s_nop 0
    v_cndmask_b32 v10, 0, v235, vcc
    v_cmp_eq_u32 vcc, 3, v40
    v_mov_b32 v39, -1
    s_nop 0
    v_cndmask_b32 v11, 0, v235, vcc
    v_lshlrev_b32 v233, 3, v1
    v_lshlrev_b32 v234, 4, v0
    s_waitcnt vmcnt(15)
    buffer_load_dwordx4 v[104:107], v4, s[40:43], s4 offen offset:128 nt
    s_waitcnt vmcnt(15)
    buffer_load_dwordx4 v[100:103], v4, s[40:43], s4 offen offset:2048 nt
    s_waitcnt vmcnt(15)
    buffer_load_dwordx4 v[96:99], v4, s[40:43], s4 offen offset:2176 nt
    s_add_u32 s4, s4, 0x8000
    s_waitcnt vmcnt(15)
    buffer_load_dwordx4 v[92:95], v4, s[40:43], s4 offen offset:0 nt
    s_waitcnt vmcnt(11)
    v_lshlrev_b32 v40, 16, v208
    v_and_b32 v41, 0xffff0000, v208
    v_lshlrev_b32 v42, 16, v209
    v_and_b32 v43, 0xffff0000, v209
    v_lshlrev_b32 v44, 16, v210
    v_and_b32 v45, 0xffff0000, v210
    v_lshlrev_b32 v46, 16, v211
    v_and_b32 v47, 0xffff0000, v211
    v_lshlrev_b32 v48, 16, v212
    v_and_b32 v49, 0xffff0000, v212
    v_add_f32 v50, v40, v41
    v_add_f32 v50, v50, v42
    v_add_f32 v50, v50, v43
    v_add_f32 v50, v50, v44
    v_add_f32 v50, v50, v45
    v_add_f32 v50, v50, v46
    v_add_f32 v50, v50, v47
    v_add_f32 v50, v50, v48
    v_add_f32 v50, v50, v49
    s_nop 1
    v_add_f32_dpp v50, v50, v50 quad_perm:[1,0,3,2] row_mask:0xf bank_mask:0xf
    s_nop 1
    v_add_f32_dpp v50, v50, v50 quad_perm:[2,3,0,1] row_mask:0xf bank_mask:0xf
    s_nop 1
    v_add_f32_dpp v50, v50, v50 row_half_mirror row_mask:0xf bank_mask:0xf
    s_nop 1
    v_add_f32_dpp v50, v50, v50 row_mirror row_mask:0xf bank_mask:0xf
    v_mov_b32 v51, v50
    s_nop 1
    v_permlane16_swap_b32 v50, v51
    s_nop 0
    v_add_f32 v50, v50, v51
    v_mov_b32 v51, v50
    s_nop 1
    v_permlane32_swap_b32 v50, v51
    s_nop 0
    v_add_f32 v50, v50, v51
    v_mul_f32 v52, 0x3acccccd, v50
    v_sub_f32 v40, v40, v52
    v_sub_f32 v41, v41, v52
    v_sub_f32 v42, v42, v52
    v_sub_f32 v43, v43, v52
    v_sub_f32 v44, v44, v52
    v_sub_f32 v45, v45, v52
    v_sub_f32 v46, v46, v52
    v_sub_f32 v47, v47, v52
    v_sub_f32 v48, v48, v52
    v_sub_f32 v49, v49, v52
    v_mul_f32 v50, v40, v40
    v_fmac_f32 v50, v41, v41
    v_fmac_f32 v50, v42, v42
    v_fmac_f32 v50, v43, v43
    v_fmac_f32 v50, v44, v44
    v_fmac_f32 v50, v45, v45
    v_fmac_f32 v50, v46, v46
    v_fmac_f32 v50, v47, v47
    v_fmac_f32 v50, v48, v48
    v_fmac_f32 v50, v49, v49
    s_nop 1
    v_add_f32_dpp v50, v50, v50 quad_perm:[1,0,3,2] row_mask:0xf bank_mask:0xf
    s_nop 1
    v_add_f32_dpp v50, v50, v50 quad_perm:[2,3,0,1] row_mask:0xf bank_mask:0xf
    s_nop 1
    v_add_f32_dpp v50, v50, v50 row_half_mirror row_mask:0xf bank_mask:0xf
    s_nop 1
    v_add_f32_dpp v50, v50, v50 row_mirror row_mask:0xf bank_mask:0xf
    v_mov_b32 v51, v50
    s_nop 1
    v_permlane16_swap_b32 v50, v51
    s_nop 0
    v_add_f32 v50, v50, v51
    v_mov_b32 v51, v50
    s_nop 1
    v_permlane32_swap_b32 v50, v51
    s_nop 0
    v_add_f32 v50, v50, v51
    v_mul_f32 v53, 0x3acccccd, v50
    s_waitcnt vmcnt(10)
    s_waitcnt vmcnt(9)
    buffer_load_dwordx4 v[88:91], v4, s[40:43], s4 offen offset:128 nt
    buffer_load_dwordx4 v[128:131], v7, s[52:55], s7 offen offset:0
    v_cvt_pk_bf16_f32 v52, v52, v52
    v_and_b32 v52, 0xffff0000, v52
    v_cvt_pk_bf16_f32 v53, v53, v53
    v_and_b32 v53, 0xffff0000, v53
    v_add_f32 v53, 0x3727c5ac, v53
    v_cvt_pk_bf16_f32 v53, v53, v53
    v_and_b32 v53, 0xffff0000, v53
    v_sqrt_f32 v53, v53
    s_nop 0
    v_cvt_pk_bf16_f32 v53, v53, v53
    v_and_b32 v53, 0xffff0000, v53
    v_rcp_f32 v51, v53
    v_lshlrev_b32 v40, 16, v213
    v_and_b32 v41, 0xffff0000, v213
    v_sub_f32 v40, v40, v52
    v_cvt_pk_bf16_f32 v40, v40, v40
    v_and_b32 v40, 0xffff0000, v40
    v_mul_f32 v44, v40, v51
    v_fma_f32 v46, -v44, v53, v40
    v_fmac_f32 v44, v46, v51
    v_cvt_pk_bf16_f32 v44, v44, v44
    v_sub_f32 v41, v41, v52
    v_cvt_pk_bf16_f32 v41, v41, v41
    v_and_b32 v41, 0xffff0000, v41
    v_mul_f32 v45, v41, v51
    v_fma_f32 v47, -v45, v53, v41
    v_fmac_f32 v45, v47, v51
    v_cvt_pk_bf16_f32 v45, v45, v45
    s_lshl_b32 s88, s3, 9
    v_add_u32 v42, s88, v233
    ds_write_b64 v42, v[44:45] offset:16384
    v_lshrrev_b32 v43, 3, v2
    v_lshlrev_b32 v43, 9, v43
    v_lshl_add_u32 v43, v3, 2, v43
    s_mul_i32 s88, s3, 80
    v_add_u32 v60, s88, v43
    v_lshrrev_b32 v40, 1, v3
    v_lshlrev_b32 v40, 9, v40
    v_and_b32 v41, 1, v3
    v_lshl_add_u32 v40, v41, 4, v40
    v_lshl_add_u32 v40, v2, 5, v40
    s_lshl_b32 s88, s3, 10
    v_add_u32 v232, s88, v40
    s_waitcnt vmcnt(10)
    buffer_load_dwordx4 a[0:3], v4, s[40:43], s4 offen offset:2048 nt
    s_waitcnt lgkmcnt(0)
    s_barrier
    ds_read_b32 v40, v60 offset:16384
    ds_read_b32 v41, v60 offset:17408
    ds_read_b32 v42, v60 offset:16400
    ds_read_b32 v43, v60 offset:17424
    ds_read_b32 v44, v60 offset:16416
    ds_read_b32 v45, v60 offset:17440
    ds_read_b32 v46, v60 offset:16432
    ds_read_b32 v47, v60 offset:17456
    ds_read_b32 v48, v60 offset:16448
    ds_read_b32 v49, v60 offset:17472
    s_waitcnt vmcnt(10)
    buffer_load_dwordx4 a[4:7], v4, s[40:43], s4 offen offset:2176 nt
    s_add_u32 s4, s4, 0x8000
    s_waitcnt lgkmcnt(0)
    v_and_b32 v12, v40, v8
    v_and_b32 v13, v40, v9
    v_and_b32 v14, v40, v10
    v_and_b32 v15, v40, v11
    v_and_b32 v16, v41, v8
    v_and_b32 v17, v41, v9
    v_and_b32 v18, v41, v10
    v_and_b32 v19, v41, v11
    v_mfma_f32_16x16x32_bf16 v[192:195], v[12:15], v[64:67], 0
    s_nop 0
    v_mfma_f32_16x16x32_bf16 v[196:199], v[16:19], v[64:67], 0
    v_and_b32 v12, v42, v8
    v_and_b32 v13, v42, v9
    v_and_b32 v14, v42, v10
    v_and_b32 v15, v42, v11
    v_and_b32 v16, v43, v8
    v_and_b32 v17, v43, v9
    v_and_b32 v18, v43, v10
    v_and_b32 v19, v43, v11
    v_mfma_f32_16x16x32_bf16 v[192:195], v[12:15], v[68:71], v[192:195]
    s_nop 0
    v_mfma_f32_16x16x32_bf16 v[196:199], v[16:19], v[68:71], v[196:199]
    v_and_b32 v12, v44, v8
    v_and_b32 v13, v44, v9
    v_and_b32 v14, v44, v10
    v_and_b32 v15, v44, v11
    v_and_b32 v16, v45, v8
    v_and_b32 v17, v45, v9
    v_and_b32 v18, v45, v10
    v_and_b32 v19, v45, v11
    v_mfma_f32_16x16x32_bf16 v[192:195], v[12:15], v[72:75], v[192:195]
    s_nop 0
    v_mfma_f32_16x16x32_bf16 v[196:199], v[16:19], v[72:75], v[196:199]
    s_waitcnt vmcnt(10)
    buffer_load_dwordx4 a[8:11], v4, s[40:43], s4 offen offset:0 nt
    buffer_load_dwordx4 v[132:135], v250, s[52:55], s7 offen offset:0
    s_waitcnt vmcnt(11)
    buffer_load_dwordx4 a[12:15], v4, s[40:43], s4 offen offset:128 nt
    v_and_b32 v12, v46, v8
    v_and_b32 v13, v46, v9
    v_and_b32 v14, v46, v10
    v_and_b32 v15, v46, v11
    v_and_b32 v16, v47, v8
    v_and_b32 v17, v47, v9
    v_and_b32 v18, v47, v10
    v_and_b32 v19, v47, v11
    v_mfma_f32_16x16x32_bf16 v[192:195], v[12:15], v[76:79], v[192:195]
    s_nop 0
    v_mfma_f32_16x16x32_bf16 v[196:199], v[16:19], v[76:79], v[196:199]
    v_and_b32 v12, v48, v8
    v_and_b32 v13, v48, v9
    v_and_b32 v14, v48, v10
    v_and_b32 v15, v48, v11
    v_and_b32 v16, v49, v8
    v_and_b32 v17, v49, v9
    v_and_b32 v18, v49, v10
    v_and_b32 v19, v49, v11
    v_mfma_f32_16x16x32_bf16 v[192:195], v[12:15], v[80:83], v[192:195]
    s_nop 0
    v_mfma_f32_16x16x32_bf16 v[196:199], v[16:19], v[80:83], v[196:199]
    s_lshr_b32 s88, s3, 1
    s_lshl_b32 s88, s88, 12
    s_and_b32 s89, s3, 1
    s_lshl_b32 s89, s89, 9
    s_add_u32 s88, s88, s89
    v_add_u32 v60, s88, v233
    s_nop 1
    ds_write_b128 v232, v[192:195] offset:18432
    ds_write_b128 v232, v[196:199] offset:22528
    s_waitcnt vmcnt(11)
    buffer_load_dwordx4 a[16:19], v4, s[40:43], s4 offen offset:2048 nt
    s_waitcnt lgkmcnt(0)
    s_barrier
    ds_read_b64 v[40:41], v60 offset:18432
    ds_read_b64 v[42:43], v60 offset:19456
    ds_read_b64 v[44:45], v60 offset:20480
    ds_read_b64 v[46:47], v60 offset:21504
    s_mul_i32 s92, s2, 5632
    s_add_u32 s92, s92, 524288
    s_mul_i32 s93, s3, 384
    s_add_u32 s93, s93, s92
    s_add_u32 s93, s93, 4096
    buffer_store_dwordx4 v[36:39], v234, s[80:83], s92 offen sc1
    s_mov_b64 exec, 0xffffff
    buffer_store_dwordx4 v[36:39], v5, s[80:83], s93 offen sc1
    s_mov_b64 exec, -1
    s_waitcnt lgkmcnt(0)
    v_pk_add_f32 v[40:41], v[40:41], v[42:43]
    v_pk_add_f32 v[44:45], v[44:45], v[46:47]
    v_pk_add_f32 v[48:49], v[40:41], v[44:45]
    buffer_store_dwordx2 v[48:49], v233, s[80:83], s22 offen sc1
    v_and_b32 v40, 7, v2
    v_lshlrev_b32 v40, 4, v40
    v_and_b32 v42, 1, v3
    v_lshl_add_u32 v237, v42, 3, v40
    s_getreg_b32 s88, hwreg(HW_REG_XCC_ID, 0, 4)
    s_and_b32 s88, s88, 7
    s_lshl_b32 s88, s88, 2
    s_lshl_b32 s35, 1, s88
    s_lshl_b32 s28, s35, 3
    s_mov_b32 s34, 1
    s_lshl_b32 s95, s8, 3
    v_mov_b32 v51, 0
    s_waitcnt vmcnt(14)
    buffer_load_dwordx4 a[20:23], v4, s[40:43], s4 offen offset:2176 nt
    s_add_u32 s4, s4, 0x8000
    buffer_load_dwordx4 v[136:139], v7, s[52:55], s7 offen offset:256
    s_waitcnt vmcnt(15)
    buffer_load_dwordx4 a[24:27], v4, s[40:43], s4 offen offset:0 nt
    s_waitcnt vmcnt(15)
    buffer_load_dwordx4 a[28:31], v4, s[40:43], s4 offen offset:128 nt
    s_waitcnt vmcnt(15)
    buffer_load_dwordx4 a[32:35], v4, s[40:43], s4 offen offset:2048 nt
    buffer_load_dwordx4 v[140:143], v250, s[52:55], s7 offen offset:256
    s_waitcnt vmcnt(16)
    buffer_load_dwordx4 a[36:39], v4, s[40:43], s4 offen offset:2176 nt
    s_add_u32 s4, s4, 0x8000
    s_waitcnt vmcnt(15)
    buffer_load_dwordx4 a[40:43], v4, s[40:43], s4 offen offset:0 nt
    s_waitcnt vmcnt(15)
    buffer_load_dwordx4 a[44:47], v4, s[40:43], s4 offen offset:128 nt
    buffer_load_dwordx4 v[144:147], v7, s[52:55], s7 offen offset:512
    s_waitcnt vmcnt(16)
    s_waitcnt vmcnt(14)
    buffer_load_dwordx4 a[48:51], v4, s[40:43], s4 offen offset:2048 nt
    s_waitcnt vmcnt(14)
    buffer_load_dwordx4 a[52:55], v4, s[40:43], s4 offen offset:2176 nt
    s_add_u32 s4, s4, 0x8000
    s_waitcnt vmcnt(11)
    buffer_load_dwordx4 a[56:59], v4, s[40:43], s4 offen offset:0 nt
    buffer_load_dwordx4 v[148:151], v250, s[52:55], s7 offen offset:512
    s_barrier
    s_cmp_lg_u32 s3, 0
    s_cbranch_scc1 L_noat
    s_atomic_add_x2 s[34:35], s[36:37], s95
L_noat:
    s_waitcnt vmcnt(11)
    buffer_load_dwordx4 a[60:63], v4, s[40:43], s4 offen offset:128 nt
    s_waitcnt vmcnt(11)
    buffer_load_dwordx4 a[64:67], v4, s[40:43], s4 offen offset:2048 nt
    s_waitcnt vmcnt(11)
    buffer_load_dwordx4 a[68:71], v4, s[40:43], s4 offen offset:2176 nt
    s_add_u32 s4, s4, 0x8000
    buffer_load_dwordx4 v[152:155], v7, s[52:55], s7 offen offset:768
    s_waitcnt vmcnt(11)
    buffer_load_dwordx4 a[72:75], v4, s[40:43], s4 offen offset:0 nt
    s_waitcnt vmcnt(11)
    buffer_load_dwordx4 a[76:79], v4, s[40:43], s4 offen offset:128 nt
    s_waitcnt vmcnt(11)
    buffer_load_dwordx4 a[80:83], v4, s[40:43], s4 offen offset:2048 nt
    buffer_load_dwordx4 v[156:159], v250, s[52:55], s7 offen offset:768
    s_waitcnt vmcnt(11)
    buffer_load_dwordx4 a[84:87], v4, s[40:43], s4 offen offset:2176 nt
    s_add_u32 s4, s4, 0x8000
    s_waitcnt vmcnt(11)
    buffer_load_dwordx4 a[88:91], v4, s[40:43], s4 offen offset:0 nt
    s_waitcnt vmcnt(11)
    buffer_load_dwordx4 a[92:95], v4, s[40:43], s4 offen offset:128 nt
    buffer_load_dwordx4 v[160:163], v7, s[52:55], s7 offen offset:1024
    s_waitcnt vmcnt(11)
    buffer_load_dwordx4 a[96:99], v4, s[40:43], s4 offen offset:2048 nt
    s_waitcnt vmcnt(11)
    buffer_load_dwordx4 a[100:103], v4, s[40:43], s4 offen offset:2176 nt
    s_add_u32 s4, s4, 0x8000
    s_waitcnt vmcnt(11)
    buffer_load_dwordx4 a[104:107], v4, s[40:43], s4 offen offset:0 nt
    buffer_load_dwordx4 v[164:167], v250, s[52:55], s7 offen offset:1024
    s_add_u32 s7, s7, 10240
    s_waitcnt vmcnt(11)
    buffer_load_dwordx4 a[108:111], v4, s[40:43], s4 offen offset:128 nt
    s_waitcnt vmcnt(11)
    buffer_load_dwordx4 a[112:115], v4, s[40:43], s4 offen offset:2048 nt
    s_waitcnt vmcnt(11)
    buffer_load_dwordx4 a[116:119], v4, s[40:43], s4 offen offset:2176 nt
    s_add_u32 s4, s4, 0x8000
    buffer_load_dwordx4 v[168:171], v7, s[52:55], s7 offen offset:0
    buffer_load_dword v220, v51, s[76:79], s95 offen sc1
    s_waitcnt vmcnt(12)
    buffer_load_dwordx4 a[120:123], v4, s[40:43], s4 offen offset:0 nt
    s_waitcnt vmcnt(12)
    buffer_load_dwordx4 a[124:127], v4, s[40:43], s4 offen offset:128 nt
    s_waitcnt vmcnt(12)
    buffer_load_dwordx4 a[128:131], v4, s[40:43], s4 offen offset:2048 nt
    buffer_load_dwordx4 v[172:175], v250, s[52:55], s7 offen offset:0
    s_waitcnt vmcnt(12)
    buffer_load_dwordx4 a[132:135], v4, s[40:43], s4 offen offset:2176 nt
    s_add_u32 s4, s4, 0x8000
    s_waitcnt vmcnt(12)
    buffer_load_dwordx4 a[136:139], v4, s[40:43], s4 offen offset:0 nt
    s_waitcnt vmcnt(12)
    buffer_load_dwordx4 a[140:143], v4, s[40:43], s4 offen offset:128 nt
    buffer_load_dwordx4 v[176:179], v7, s[52:55], s7 offen offset:256
    s_waitcnt vmcnt(12)
    buffer_load_dwordx4 a[144:147], v4, s[40:43], s4 offen offset:2048 nt
    s_waitcnt vmcnt(12)
    buffer_load_dwordx4 a[148:151], v4, s[40:43], s4 offen offset:2176 nt
    s_add_u32 s4, s4, 0x8000
    s_waitcnt vmcnt(12)
    buffer_load_dwordx4 a[152:155], v4, s[40:43], s4 offen offset:0 nt
    buffer_load_dwordx4 v[180:183], v250, s[52:55], s7 offen offset:256
    s_waitcnt vmcnt(11)
    buffer_load_dwordx4 a[156:159], v4, s[40:43], s4 offen offset:128 nt
    s_mov_b32 s88, 1048576
L_hclp_2:
    v_cmp_gt_u32 vcc, 8, v220
    s_cbranch_vccz L_hcok_1
    s_sub_u32 s88, s88, 1
    s_cbranch_scc1 L_hcok_1
    buffer_load_dword v220, v51, s[76:79], s95 offen sc1
    s_waitcnt vmcnt(0)
    s_branch L_hclp_2
L_hcok_1:
    buffer_load_dwordx4 v[200:203], v5, s[80:83], s23 offen sc1
    s_waitcnt vmcnt(12)
    buffer_load_dwordx4 a[160:163], v4, s[40:43], s4 offen offset:2048 nt
    s_waitcnt vmcnt(12)
    buffer_load_dwordx4 a[164:167], v4, s[40:43], s4 offen offset:2176 nt
    s_add_u32 s4, s4, 0x8000
    buffer_load_dwordx4 v[184:187], v7, s[52:55], s7 offen offset:512
    s_waitcnt vmcnt(12)
    buffer_load_dwordx4 a[168:171], v4, s[40:43], s4 offen offset:0 nt
    s_waitcnt vmcnt(12)
    buffer_load_dwordx4 a[172:175], v4, s[40:43], s4 offen offset:128 nt
    s_waitcnt vmcnt(12)
    buffer_load_dwordx4 a[176:179], v4, s[40:43], s4 offen offset:2048 nt
    buffer_load_dwordx4 v[188:191], v250, s[52:55], s7 offen offset:512
    s_waitcnt vmcnt(12)
    buffer_load_dwordx4 a[180:183], v4, s[40:43], s4 offen offset:2176 nt
    s_add_u32 s4, s4, 0x8000
    s_waitcnt vmcnt(12)
    buffer_load_dwordx4 a[184:187], v4, s[40:43], s4 offen offset:0 nt
    s_waitcnt vmcnt(12)
    buffer_load_dwordx4 a[188:191], v4, s[40:43], s4 offen offset:128 nt
    buffer_load_dwordx4 a[192:195], v7, s[52:55], s7 offen offset:768
    s_waitcnt vmcnt(12)
    buffer_load_dwordx4 a[200:203], v4, s[40:43], s4 offen offset:2048 nt
    s_waitcnt vmcnt(11)
    buffer_load_dwordx4 a[204:207], v4, s[40:43], s4 offen offset:2176 nt
    s_add_u32 s4, s4, 0x8000
    ds_write_b128 v234, v[200:203] offset:26624
    s_lshl_b32 s88, s3, 8
    v_lshl_add_u32 v58, v1, 2, s88
    v_and_b32 v59, 1, v2
    v_lshlrev_b32 v59, 4, v59
    v_lshl_add_u32 v59, v3, 5, v59
    v_add_u32 v59, s88, v59
    s_waitcnt vmcnt(11)
    buffer_load_dwordx4 a[208:211], v4, s[40:43], s4 offen offset:0 nt
    buffer_load_dwordx4 a[196:199], v250, s[52:55], s7 offen offset:768
    s_waitcnt lgkmcnt(0)
    s_barrier
    ds_read_b64 v[40:41], v233 offset:26624
    ds_read_b64 v[42:43], v233 offset:27136
    ds_read_b64 v[44:45], v233 offset:27648
    ds_read_b64 v[46:47], v233 offset:28160
    ds_read_b64 v[48:49], v233 offset:28672
    ds_read_b64 v[50:51], v233 offset:29184
    ds_read_b64 v[52:53], v233 offset:29696
    ds_read_b64 v[54:55], v233 offset:30208
    s_waitcnt vmcnt(11)
    buffer_load_dwordx4 a[212:215], v4, s[40:43], s4 offen offset:128 nt
    s_waitcnt lgkmcnt(0)
    v_pk_add_f32 v[40:41], v[40:41], v[42:43]
    v_pk_add_f32 v[44:45], v[44:45], v[46:47]
    v_pk_add_f32 v[48:49], v[48:49], v[50:51]
    v_pk_add_f32 v[52:53], v[52:53], v[54:55]
    v_pk_add_f32 v[40:41], v[40:41], v[44:45]
    v_pk_add_f32 v[48:49], v[48:49], v[52:53]
    v_pk_add_f32 v[40:41], v[40:41], v[48:49]
    v_cvt_pk_bf16_f32 v40, v40, v41
    ds_write_b32 v58, v40 offset:30720
    s_waitcnt lgkmcnt(0)
    ds_read_b128 v[24:27], v59 offset:30720
    ds_read_b128 v[28:31], v59 offset:30848
    s_waitcnt vmcnt(11)
    buffer_load_dwordx4 a[216:219], v4, s[40:43], s4 offen offset:2048 nt
    s_waitcnt lgkmcnt(0)
    v_mfma_f32_16x16x32_bf16 v[192:195], v[124:127], v[24:27], 0
    v_mfma_f32_16x16x32_bf16 v[192:195], v[120:123], v[28:31], v[192:195]
    v_mfma_f32_16x16x32_bf16 v[196:199], v[116:119], v[24:27], 0
    v_mfma_f32_16x16x32_bf16 v[196:199], v[112:115], v[28:31], v[196:199]
    v_mfma_f32_16x16x32_bf16 v[200:203], v[108:111], v[24:27], 0
    v_mfma_f32_16x16x32_bf16 v[200:203], v[104:107], v[28:31], v[200:203]
    v_mfma_f32_16x16x32_bf16 v[204:207], v[100:103], v[24:27], 0
    v_mfma_f32_16x16x32_bf16 v[204:207], v[96:99], v[28:31], v[204:207]
    s_lshl_b64 s[98:99], s[96:97], 0
    s_lshl_b64 s[100:101], s[96:97], 1
    v_add_f32_dpp v192, v193, v192 quad_perm:[1,0,3,2] row_mask:0xf bank_mask:0xf
    v_add_f32_dpp v195, v194, v195 quad_perm:[1,0,3,2] row_mask:0xf bank_mask:0xf
    v_cndmask_b32 v32, v32, v192, s[98:99]
    v_cndmask_b32 v32, v32, v195, s[100:101]
    s_lshl_b64 s[98:99], s[96:97], 2
    s_lshl_b64 s[100:101], s[96:97], 3
    v_add_f32_dpp v196, v197, v196 quad_perm:[1,0,3,2] row_mask:0xf bank_mask:0xf
    v_add_f32_dpp v199, v198, v199 quad_perm:[1,0,3,2] row_mask:0xf bank_mask:0xf
    v_cndmask_b32 v32, v32, v196, s[98:99]
    v_cndmask_b32 v32, v32, v199, s[100:101]
    s_lshl_b64 s[98:99], s[96:97], 4
    s_lshl_b64 s[100:101], s[96:97], 5
    v_add_f32_dpp v200, v201, v200 quad_perm:[1,0,3,2] row_mask:0xf bank_mask:0xf
    v_add_f32_dpp v203, v202, v203 quad_perm:[1,0,3,2] row_mask:0xf bank_mask:0xf
    v_cndmask_b32 v32, v32, v200, s[98:99]
    v_cndmask_b32 v32, v32, v203, s[100:101]
    s_lshl_b64 s[98:99], s[96:97], 6
    s_lshl_b64 s[100:101], s[96:97], 7
    v_add_f32_dpp v204, v205, v204 quad_perm:[1,0,3,2] row_mask:0xf bank_mask:0xf
    v_add_f32_dpp v207, v206, v207 quad_perm:[1,0,3,2] row_mask:0xf bank_mask:0xf
    v_cndmask_b32 v32, v32, v204, s[98:99]
    v_cndmask_b32 v32, v32, v207, s[100:101]
    v_mfma_f32_16x16x32_bf16 v[192:195], v[92:95], v[24:27], 0
    v_mfma_f32_16x16x32_bf16 v[192:195], v[88:91], v[28:31], v[192:195]
    v_mfma_f32_16x16x32_bf16 v[196:199], a[0:3], v[24:27], 0
    v_mfma_f32_16x16x32_bf16 v[196:199], a[4:7], v[28:31], v[196:199]
    v_mfma_f32_16x16x32_bf16 v[200:203], a[8:11], v[24:27], 0
    v_mfma_f32_16x16x32_bf16 v[200:203], a[12:15], v[28:31], v[200:203]
    v_mfma_f32_16x16x32_bf16 v[204:207], a[16:19], v[24:27], 0
    v_mfma_f32_16x16x32_bf16 v[204:207], a[20:23], v[28:31], v[204:207]
    s_lshl_b64 s[98:99], s[96:97], 8
    s_lshl_b64 s[100:101], s[96:97], 9
    v_add_f32_dpp v192, v193, v192 quad_perm:[1,0,3,2] row_mask:0xf bank_mask:0xf
    v_add_f32_dpp v195, v194, v195 quad_perm:[1,0,3,2] row_mask:0xf bank_mask:0xf
    v_cndmask_b32 v32, v32, v192, s[98:99]
    v_cndmask_b32 v32, v32, v195, s[100:101]
    s_lshl_b64 s[98:99], s[96:97], 10
    s_lshl_b64 s[100:101], s[96:97], 11
    v_add_f32_dpp v196, v197, v196 quad_perm:[1,0,3,2] row_mask:0xf bank_mask:0xf
    v_add_f32_dpp v199, v198, v199 quad_perm:[1,0,3,2] row_mask:0xf bank_mask:0xf
    v_cndmask_b32 v32, v32, v196, s[98:99]
    v_cndmask_b32 v32, v32, v199, s[100:101]
    s_lshl_b64 s[98:99], s[96:97], 12
    s_lshl_b64 s[100:101], s[96:97], 13
    v_add_f32_dpp v200, v201, v200 quad_perm:[1,0,3,2] row_mask:0xf bank_mask:0xf
    v_add_f32_dpp v203, v202, v203 quad_perm:[1,0,3,2] row_mask:0xf bank_mask:0xf
    v_cndmask_b32 v32, v32, v200, s[98:99]
    v_cndmask_b32 v32, v32, v203, s[100:101]
    s_lshl_b64 s[98:99], s[96:97], 14
    s_lshl_b64 s[100:101], s[96:97], 15
    v_add_f32_dpp v204, v205, v204 quad_perm:[1,0,3,2] row_mask:0xf bank_mask:0xf
    v_add_f32_dpp v207, v206, v207 quad_perm:[1,0,3,2] row_mask:0xf bank_mask:0xf
    v_cndmask_b32 v32, v32, v204, s[98:99]
    v_cndmask_b32 v32, v32, v207, s[100:101]
    s_waitcnt vmcnt(11)
    buffer_load_dwordx4 a[220:223], v4, s[40:43], s4 offen offset:2176 nt
    s_add_u32 s4, s4, 0x8000
    buffer_load_dwordx4 a[224:227], v7, s[52:55], s7 offen offset:1024
    v_mfma_f32_16x16x32_bf16 v[192:195], a[24:27], v[24:27], 0
    v_mfma_f32_16x16x32_bf16 v[192:195], a[28:31], v[28:31], v[192:195]
    v_mfma_f32_16x16x32_bf16 v[196:199], a[32:35], v[24:27], 0
    v_mfma_f32_16x16x32_bf16 v[196:199], a[36:39], v[28:31], v[196:199]
    v_mfma_f32_16x16x32_bf16 v[200:203], a[40:43], v[24:27], 0
    v_mfma_f32_16x16x32_bf16 v[200:203], a[44:47], v[28:31], v[200:203]
    v_mfma_f32_16x16x32_bf16 v[204:207], a[48:51], v[24:27], 0
    v_mfma_f32_16x16x32_bf16 v[204:207], a[52:55], v[28:31], v[204:207]
    s_lshl_b64 s[98:99], s[96:97], 0
    s_lshl_b64 s[100:101], s[96:97], 1
    v_add_f32_dpp v192, v193, v192 quad_perm:[1,0,3,2] row_mask:0xf bank_mask:0xf
    v_add_f32_dpp v195, v194, v195 quad_perm:[1,0,3,2] row_mask:0xf bank_mask:0xf
    v_cndmask_b32 v33, v33, v192, s[98:99]
    v_cndmask_b32 v33, v33, v195, s[100:101]
    s_lshl_b64 s[98:99], s[96:97], 2
    s_lshl_b64 s[100:101], s[96:97], 3
    v_add_f32_dpp v196, v197, v196 quad_perm:[1,0,3,2] row_mask:0xf bank_mask:0xf
    v_add_f32_dpp v199, v198, v199 quad_perm:[1,0,3,2] row_mask:0xf bank_mask:0xf
    v_cndmask_b32 v33, v33, v196, s[98:99]
    v_cndmask_b32 v33, v33, v199, s[100:101]
    s_lshl_b64 s[98:99], s[96:97], 4
    s_lshl_b64 s[100:101], s[96:97], 5
    v_add_f32_dpp v200, v201, v200 quad_perm:[1,0,3,2] row_mask:0xf bank_mask:0xf
    v_add_f32_dpp v203, v202, v203 quad_perm:[1,0,3,2] row_mask:0xf bank_mask:0xf
    v_cndmask_b32 v33, v33, v200, s[98:99]
    v_cndmask_b32 v33, v33, v203, s[100:101]
    s_lshl_b64 s[98:99], s[96:97], 6
    s_lshl_b64 s[100:101], s[96:97], 7
    v_add_f32_dpp v204, v205, v204 quad_perm:[1,0,3,2] row_mask:0xf bank_mask:0xf
    v_add_f32_dpp v207, v206, v207 quad_perm:[1,0,3,2] row_mask:0xf bank_mask:0xf
    v_cndmask_b32 v33, v33, v204, s[98:99]
    v_cndmask_b32 v33, v33, v207, s[100:101]
    s_waitcnt vmcnt(11)
    buffer_load_dwordx4 v[84:87], v5, s[44:47], s5 offen offset:0 nt
    v_mfma_f32_16x16x32_bf16 v[192:195], a[56:59], v[24:27], 0
    v_mfma_f32_16x16x32_bf16 v[192:195], a[60:63], v[28:31], v[192:195]
    v_mfma_f32_16x16x32_bf16 v[196:199], a[64:67], v[24:27], 0
    v_mfma_f32_16x16x32_bf16 v[196:199], a[68:71], v[28:31], v[196:199]
    v_mfma_f32_16x16x32_bf16 v[200:203], a[72:75], v[24:27], 0
    v_mfma_f32_16x16x32_bf16 v[200:203], a[76:79], v[28:31], v[200:203]
    v_mfma_f32_16x16x32_bf16 v[204:207], a[80:83], v[24:27], 0
    v_mfma_f32_16x16x32_bf16 v[204:207], a[84:87], v[28:31], v[204:207]
    s_lshl_b64 s[98:99], s[96:97], 8
    s_lshl_b64 s[100:101], s[96:97], 9
    v_add_f32_dpp v192, v193, v192 quad_perm:[1,0,3,2] row_mask:0xf bank_mask:0xf
    v_add_f32_dpp v195, v194, v195 quad_perm:[1,0,3,2] row_mask:0xf bank_mask:0xf
    v_cndmask_b32 v33, v33, v192, s[98:99]
    v_cndmask_b32 v33, v33, v195, s[100:101]
    s_lshl_b64 s[98:99], s[96:97], 10
    s_lshl_b64 s[100:101], s[96:97], 11
    v_add_f32_dpp v196, v197, v196 quad_perm:[1,0,3,2] row_mask:0xf bank_mask:0xf
    v_add_f32_dpp v199, v198, v199 quad_perm:[1,0,3,2] row_mask:0xf bank_mask:0xf
    v_cndmask_b32 v33, v33, v196, s[98:99]
    v_cndmask_b32 v33, v33, v199, s[100:101]
    s_lshl_b64 s[98:99], s[96:97], 12
    s_lshl_b64 s[100:101], s[96:97], 13
    v_add_f32_dpp v200, v201, v200 quad_perm:[1,0,3,2] row_mask:0xf bank_mask:0xf
    v_add_f32_dpp v203, v202, v203 quad_perm:[1,0,3,2] row_mask:0xf bank_mask:0xf
    v_cndmask_b32 v33, v33, v200, s[98:99]
    v_cndmask_b32 v33, v33, v203, s[100:101]
    s_lshl_b64 s[98:99], s[96:97], 14
    s_lshl_b64 s[100:101], s[96:97], 15
    v_add_f32_dpp v204, v205, v204 quad_perm:[1,0,3,2] row_mask:0xf bank_mask:0xf
    v_add_f32_dpp v207, v206, v207 quad_perm:[1,0,3,2] row_mask:0xf bank_mask:0xf
    v_cndmask_b32 v33, v33, v204, s[98:99]
    v_cndmask_b32 v33, v33, v207, s[100:101]
    s_waitcnt vmcnt(11)
    buffer_load_dwordx4 v[88:91], v5, s[44:47], s5 offen offset:1024 nt
    v_mfma_f32_16x16x32_bf16 v[192:195], a[88:91], v[24:27], 0
    v_mfma_f32_16x16x32_bf16 v[192:195], a[92:95], v[28:31], v[192:195]
    v_mfma_f32_16x16x32_bf16 v[196:199], a[96:99], v[24:27], 0
    v_mfma_f32_16x16x32_bf16 v[196:199], a[100:103], v[28:31], v[196:199]
    v_mfma_f32_16x16x32_bf16 v[200:203], a[104:107], v[24:27], 0
    v_mfma_f32_16x16x32_bf16 v[200:203], a[108:111], v[28:31], v[200:203]
    v_mfma_f32_16x16x32_bf16 v[204:207], a[112:115], v[24:27], 0
    v_mfma_f32_16x16x32_bf16 v[204:207], a[116:119], v[28:31], v[204:207]
    s_lshl_b64 s[98:99], s[96:97], 0
    s_lshl_b64 s[100:101], s[96:97], 1
    v_add_f32_dpp v192, v193, v192 quad_perm:[1,0,3,2] row_mask:0xf bank_mask:0xf
    v_add_f32_dpp v195, v194, v195 quad_perm:[1,0,3,2] row_mask:0xf bank_mask:0xf
    v_cndmask_b32 v34, v34, v192, s[98:99]
    v_cndmask_b32 v34, v34, v195, s[100:101]
    s_lshl_b64 s[98:99], s[96:97], 2
    s_lshl_b64 s[100:101], s[96:97], 3
    v_add_f32_dpp v196, v197, v196 quad_perm:[1,0,3,2] row_mask:0xf bank_mask:0xf
    v_add_f32_dpp v199, v198, v199 quad_perm:[1,0,3,2] row_mask:0xf bank_mask:0xf
    v_cndmask_b32 v34, v34, v196, s[98:99]
    v_cndmask_b32 v34, v34, v199, s[100:101]
    s_lshl_b64 s[98:99], s[96:97], 4
    s_lshl_b64 s[100:101], s[96:97], 5
    v_add_f32_dpp v200, v201, v200 quad_perm:[1,0,3,2] row_mask:0xf bank_mask:0xf
    v_add_f32_dpp v203, v202, v203 quad_perm:[1,0,3,2] row_mask:0xf bank_mask:0xf
    v_cndmask_b32 v34, v34, v200, s[98:99]
    v_cndmask_b32 v34, v34, v203, s[100:101]
    s_lshl_b64 s[98:99], s[96:97], 6
    s_lshl_b64 s[100:101], s[96:97], 7
    v_add_f32_dpp v204, v205, v204 quad_perm:[1,0,3,2] row_mask:0xf bank_mask:0xf
    v_add_f32_dpp v207, v206, v207 quad_perm:[1,0,3,2] row_mask:0xf bank_mask:0xf
    v_cndmask_b32 v34, v34, v204, s[98:99]
    v_cndmask_b32 v34, v34, v207, s[100:101]
    s_waitcnt vmcnt(11)
    buffer_load_dwordx4 v[92:95], v5, s[44:47], s5 offen offset:2048 nt
    buffer_load_dwordx4 a[228:231], v250, s[52:55], s7 offen offset:1024
    s_add_u32 s7, s7, 10240
    v_mfma_f32_16x16x32_bf16 v[192:195], a[120:123], v[24:27], 0
    v_mfma_f32_16x16x32_bf16 v[192:195], a[124:127], v[28:31], v[192:195]
    v_mfma_f32_16x16x32_bf16 v[196:199], a[128:131], v[24:27], 0
    v_mfma_f32_16x16x32_bf16 v[196:199], a[132:135], v[28:31], v[196:199]
    v_mfma_f32_16x16x32_bf16 v[200:203], a[136:139], v[24:27], 0
    v_mfma_f32_16x16x32_bf16 v[200:203], a[140:143], v[28:31], v[200:203]
    v_mfma_f32_16x16x32_bf16 v[204:207], a[144:147], v[24:27], 0
    v_mfma_f32_16x16x32_bf16 v[204:207], a[148:151], v[28:31], v[204:207]
    s_lshl_b64 s[98:99], s[96:97], 8
    s_lshl_b64 s[100:101], s[96:97], 9
    v_add_f32_dpp v192, v193, v192 quad_perm:[1,0,3,2] row_mask:0xf bank_mask:0xf
    v_add_f32_dpp v195, v194, v195 quad_perm:[1,0,3,2] row_mask:0xf bank_mask:0xf
    v_cndmask_b32 v34, v34, v192, s[98:99]
    v_cndmask_b32 v34, v34, v195, s[100:101]
    s_lshl_b64 s[98:99], s[96:97], 10
    s_lshl_b64 s[100:101], s[96:97], 11
    v_add_f32_dpp v196, v197, v196 quad_perm:[1,0,3,2] row_mask:0xf bank_mask:0xf
    v_add_f32_dpp v199, v198, v199 quad_perm:[1,0,3,2] row_mask:0xf bank_mask:0xf
    v_cndmask_b32 v34, v34, v196, s[98:99]
    v_cndmask_b32 v34, v34, v199, s[100:101]
    s_lshl_b64 s[98:99], s[96:97], 12
    s_lshl_b64 s[100:101], s[96:97], 13
    v_add_f32_dpp v200, v201, v200 quad_perm:[1,0,3,2] row_mask:0xf bank_mask:0xf
    v_add_f32_dpp v203, v202, v203 quad_perm:[1,0,3,2] row_mask:0xf bank_mask:0xf
    v_cndmask_b32 v34, v34, v200, s[98:99]
    v_cndmask_b32 v34, v34, v203, s[100:101]
    s_lshl_b64 s[98:99], s[96:97], 14
    s_lshl_b64 s[100:101], s[96:97], 15
    v_add_f32_dpp v204, v205, v204 quad_perm:[1,0,3,2] row_mask:0xf bank_mask:0xf
    v_add_f32_dpp v207, v206, v207 quad_perm:[1,0,3,2] row_mask:0xf bank_mask:0xf
    v_cndmask_b32 v34, v34, v204, s[98:99]
    v_cndmask_b32 v34, v34, v207, s[100:101]
    v_and_b32 v242, 31, v1
    v_lshlrev_b32 v242, 3, v242
    buffer_load_dwordx2 v[220:221], v242, s[76:79], 0 offen sc1
    v_mfma_f32_16x16x32_bf16 v[192:195], a[152:155], v[24:27], 0
    v_mfma_f32_16x16x32_bf16 v[192:195], a[156:159], v[28:31], v[192:195]
    v_mfma_f32_16x16x32_bf16 v[196:199], a[160:163], v[24:27], 0
    v_mfma_f32_16x16x32_bf16 v[196:199], a[164:167], v[28:31], v[196:199]
    v_mfma_f32_16x16x32_bf16 v[200:203], a[168:171], v[24:27], 0
    v_mfma_f32_16x16x32_bf16 v[200:203], a[172:175], v[28:31], v[200:203]
    v_mfma_f32_16x16x32_bf16 v[204:207], a[176:179], v[24:27], 0
    v_mfma_f32_16x16x32_bf16 v[204:207], a[180:183], v[28:31], v[204:207]
    s_lshl_b64 s[98:99], s[96:97], 0
    s_lshl_b64 s[100:101], s[96:97], 1
    v_add_f32_dpp v192, v193, v192 quad_perm:[1,0,3,2] row_mask:0xf bank_mask:0xf
    v_add_f32_dpp v195, v194, v195 quad_perm:[1,0,3,2] row_mask:0xf bank_mask:0xf
    v_cndmask_b32 v35, v35, v192, s[98:99]
    v_cndmask_b32 v35, v35, v195, s[100:101]
    s_lshl_b64 s[98:99], s[96:97], 2
    s_lshl_b64 s[100:101], s[96:97], 3
    v_add_f32_dpp v196, v197, v196 quad_perm:[1,0,3,2] row_mask:0xf bank_mask:0xf
    v_add_f32_dpp v199, v198, v199 quad_perm:[1,0,3,2] row_mask:0xf bank_mask:0xf
    v_cndmask_b32 v35, v35, v196, s[98:99]
    v_cndmask_b32 v35, v35, v199, s[100:101]
    s_lshl_b64 s[98:99], s[96:97], 4
    s_lshl_b64 s[100:101], s[96:97], 5
    v_add_f32_dpp v200, v201, v200 quad_perm:[1,0,3,2] row_mask:0xf bank_mask:0xf
    v_add_f32_dpp v203, v202, v203 quad_perm:[1,0,3,2] row_mask:0xf bank_mask:0xf
    v_cndmask_b32 v35, v35, v200, s[98:99]
    v_cndmask_b32 v35, v35, v203, s[100:101]
    s_lshl_b64 s[98:99], s[96:97], 6
    s_lshl_b64 s[100:101], s[96:97], 7
    v_add_f32_dpp v204, v205, v204 quad_perm:[1,0,3,2] row_mask:0xf bank_mask:0xf
    v_add_f32_dpp v207, v206, v207 quad_perm:[1,0,3,2] row_mask:0xf bank_mask:0xf
    v_cndmask_b32 v35, v35, v204, s[98:99]
    v_cndmask_b32 v35, v35, v207, s[100:101]
    s_waitcnt vmcnt(12)
    buffer_load_dwordx4 v[96:99], v5, s[44:47], s5 offen offset:3072 nt
    s_add_u32 s5, s5, 0x8000
    s_waitcnt vmcnt(12)
    buffer_load_dwordx4 v[100:103], v5, s[44:47], s5 offen offset:0 nt
    buffer_load_dwordx4 a[232:235], v7, s[52:55], s7 offen offset:0
    s_waitcnt vmcnt(13)
    buffer_load_dwordx4 v[104:107], v5, s[44:47], s5 offen offset:1024 nt
    s_waitcnt vmcnt(12)
    buffer_load_dwordx4 v[108:111], v5, s[44:47], s5 offen offset:2048 nt
    s_waitcnt vmcnt(12)
    buffer_load_dwordx4 v[112:115], v5, s[44:47], s5 offen offset:3072 nt
    s_add_u32 s5, s5, 0x8000
    buffer_load_dwordx4 a[236:239], v250, s[52:55], s7 offen offset:0
    s_waitcnt vmcnt(13)
    buffer_load_dwordx4 v[116:119], v5, s[44:47], s5 offen offset:0 nt
    v_mfma_f32_16x16x32_bf16 v[192:195], a[184:187], v[24:27], 0
    v_mfma_f32_16x16x32_bf16 v[192:195], a[188:191], v[28:31], v[192:195]
    v_mfma_f32_16x16x32_bf16 v[196:199], a[200:203], v[24:27], 0
    v_mfma_f32_16x16x32_bf16 v[196:199], a[204:207], v[28:31], v[196:199]
    v_mfma_f32_16x16x32_bf16 v[200:203], a[208:211], v[24:27], 0
    v_mfma_f32_16x16x32_bf16 v[200:203], a[212:215], v[28:31], v[200:203]
    v_mfma_f32_16x16x32_bf16 v[204:207], a[216:219], v[24:27], 0
    v_mfma_f32_16x16x32_bf16 v[204:207], a[220:223], v[28:31], v[204:207]
    s_lshl_b64 s[98:99], s[96:97], 8
    s_lshl_b64 s[100:101], s[96:97], 9
    v_add_f32_dpp v192, v193, v192 quad_perm:[1,0,3,2] row_mask:0xf bank_mask:0xf
    v_add_f32_dpp v195, v194, v195 quad_perm:[1,0,3,2] row_mask:0xf bank_mask:0xf
    v_cndmask_b32 v35, v35, v192, s[98:99]
    v_cndmask_b32 v35, v35, v195, s[100:101]
    s_lshl_b64 s[98:99], s[96:97], 10
    s_lshl_b64 s[100:101], s[96:97], 11
    v_add_f32_dpp v196, v197, v196 quad_perm:[1,0,3,2] row_mask:0xf bank_mask:0xf
    v_add_f32_dpp v199, v198, v199 quad_perm:[1,0,3,2] row_mask:0xf bank_mask:0xf
    v_cndmask_b32 v35, v35, v196, s[98:99]
    v_cndmask_b32 v35, v35, v199, s[100:101]
    s_lshl_b64 s[98:99], s[96:97], 12
    s_lshl_b64 s[100:101], s[96:97], 13
    v_add_f32_dpp v200, v201, v200 quad_perm:[1,0,3,2] row_mask:0xf bank_mask:0xf
    v_add_f32_dpp v203, v202, v203 quad_perm:[1,0,3,2] row_mask:0xf bank_mask:0xf
    v_cndmask_b32 v35, v35, v200, s[98:99]
    v_cndmask_b32 v35, v35, v203, s[100:101]
    s_lshl_b64 s[98:99], s[96:97], 14
    s_lshl_b64 s[100:101], s[96:97], 15
    v_add_f32_dpp v204, v205, v204 quad_perm:[1,0,3,2] row_mask:0xf bank_mask:0xf
    v_add_f32_dpp v207, v206, v207 quad_perm:[1,0,3,2] row_mask:0xf bank_mask:0xf
    v_cndmask_b32 v35, v35, v204, s[98:99]
    v_cndmask_b32 v35, v35, v207, s[100:101]
    v_cvt_pk_bf16_f32 v32, v32, v32
    v_and_b32 v32, 0xffff0000, v32
    v_mul_f32 v32, 0x3db504f3, v32
    v_cvt_pk_bf16_f32 v32, v32, v32
    v_and_b32 v32, 0xffff0000, v32
    v_cvt_pk_bf16_f32 v33, v33, v33
    v_and_b32 v33, 0xffff0000, v33
    v_mul_f32 v33, 0x3db504f3, v33
    v_cvt_pk_bf16_f32 v33, v33, v33
    v_and_b32 v33, 0xffff0000, v33
    v_cvt_pk_bf16_f32 v34, v34, v34
    v_and_b32 v34, 0xffff0000, v34
    v_mul_f32 v34, 0x3db504f3, v34
    v_cvt_pk_bf16_f32 v34, v34, v34
    v_and_b32 v34, 0xffff0000, v34
    v_cvt_pk_bf16_f32 v35, v35, v35
    v_and_b32 v35, 0xffff0000, v35
    v_mul_f32 v35, 0x3db504f3, v35
    v_cvt_pk_bf16_f32 v35, v35, v35
    v_and_b32 v35, 0xffff0000, v35
    v_max3_f32 v216, v32, v33, v34
    v_max_f32 v216, v216, v35
    s_nop 1
    v_max_f32_dpp v216, v216, v216 quad_perm:[1,0,3,2] row_mask:0xf bank_mask:0xf
    s_nop 1
    v_max_f32_dpp v216, v216, v216 quad_perm:[2,3,0,1] row_mask:0xf bank_mask:0xf
    s_nop 1
    v_max_f32_dpp v216, v216, v216 row_half_mirror row_mask:0xf bank_mask:0xf
    s_nop 1
    v_max_f32_dpp v216, v216, v216 row_mirror row_mask:0xf bank_mask:0xf
    v_mov_b32 v40, v216
    s_nop 1
    v_permlane16_swap_b32 v216, v40
    s_nop 0
    v_max_f32 v216, v216, v40
    v_mov_b32 v40, v216
    s_nop 1
    v_permlane32_swap_b32 v216, v40
    s_nop 0
    v_max_f32 v216, v216, v40
    s_waitcnt vmcnt(12)
    buffer_load_dwordx4 v[120:123], v5, s[44:47], s5 offen offset:1024 nt
    v_sub_f32 v32, v32, v216
    v_mul_f32 v32, 0x3fb8aa3b, v32
    v_exp_f32 v32, v32
    v_sub_f32 v33, v33, v216
    v_mul_f32 v33, 0x3fb8aa3b, v33
    v_exp_f32 v33, v33
    v_sub_f32 v34, v34, v216
    v_mul_f32 v34, 0x3fb8aa3b, v34
    v_exp_f32 v34, v34
    v_sub_f32 v35, v35, v216
    v_mul_f32 v35, 0x3fb8aa3b, v35
    v_exp_f32 v35, v35
    s_nop 0
    v_add_f32 v217, v32, v33
    v_add_f32 v41, v34, v35
    v_add_f32 v217, v217, v41
    v_cvt_pk_bf16_f32 v32, v32, v32
    v_cvt_pk_bf16_f32 v33, v33, v33
    v_cvt_pk_bf16_f32 v34, v34, v34
    v_cvt_pk_bf16_f32 v35, v35, v35
    v_add_f32_dpp v217, v217, v217 quad_perm:[1,0,3,2] row_mask:0xf bank_mask:0xf
    s_nop 1
    v_add_f32_dpp v217, v217, v217 quad_perm:[2,3,0,1] row_mask:0xf bank_mask:0xf
    s_nop 1
    v_add_f32_dpp v217, v217, v217 row_half_mirror row_mask:0xf bank_mask:0xf
    s_nop 1
    v_add_f32_dpp v217, v217, v217 row_mirror row_mask:0xf bank_mask:0xf
    v_mov_b32 v40, v217
    s_nop 1
    v_permlane16_swap_b32 v217, v40
    s_nop 0
    v_add_f32 v217, v217, v40
    v_mov_b32 v40, v217
    s_nop 1
    v_permlane32_swap_b32 v217, v40
    s_nop 0
    v_add_f32 v217, v217, v40
    s_lshl_b32 s88, s3, 3
    v_mov_b32 v40, s88
    ds_write_b64 v40, v[216:217] offset:15360
    s_waitcnt vmcnt(12)
    buffer_load_dwordx4 v[124:127], v5, s[44:47], s5 offen offset:2048 nt
    buffer_load_dwordx4 a[240:243], v7, s[52:55], s7 offen offset:256
    v_and_b32_dpp v12, v32, v8 row_newbcast:0 row_mask:0xf bank_mask:0xf
    v_and_b32_dpp v13, v32, v9 row_newbcast:0 row_mask:0xf bank_mask:0xf
    v_and_b32_dpp v14, v32, v10 row_newbcast:0 row_mask:0xf bank_mask:0xf
    v_and_b32_dpp v15, v32, v11 row_newbcast:0 row_mask:0xf bank_mask:0xf
    s_nop 1
    v_mfma_f32_16x16x32_bf16 v[20:23], v[12:15], v[84:87], 0
    v_and_b32_dpp v16, v32, v8 row_newbcast:1 row_mask:0xf bank_mask:0xf
    v_and_b32_dpp v17, v32, v9 row_newbcast:1 row_mask:0xf bank_mask:0xf
    v_and_b32_dpp v18, v32, v10 row_newbcast:1 row_mask:0xf bank_mask:0xf
    v_and_b32_dpp v19, v32, v11 row_newbcast:1 row_mask:0xf bank_mask:0xf
    s_nop 1
    v_mfma_f32_16x16x32_bf16 v[20:23], v[16:19], v[88:91], v[20:23]
    s_waitcnt vmcnt(13)
    buffer_load_dwordx4 v[64:67], v5, s[44:47], s5 offen offset:3072 nt
    s_add_u32 s5, s5, 0x8000
    v_and_b32_dpp v12, v32, v8 row_newbcast:2 row_mask:0xf bank_mask:0xf
    v_and_b32_dpp v13, v32, v9 row_newbcast:2 row_mask:0xf bank_mask:0xf
    v_and_b32_dpp v14, v32, v10 row_newbcast:2 row_mask:0xf bank_mask:0xf
    v_and_b32_dpp v15, v32, v11 row_newbcast:2 row_mask:0xf bank_mask:0xf
    s_nop 1
    v_mfma_f32_16x16x32_bf16 v[20:23], v[12:15], v[92:95], v[20:23]
    s_waitcnt vmcnt(11)
    buffer_load_dwordx4 v[68:71], v5, s[44:47], s5 offen offset:0 nt
    v_and_b32_dpp v16, v32, v8 row_newbcast:3 row_mask:0xf bank_mask:0xf
    v_and_b32_dpp v17, v32, v9 row_newbcast:3 row_mask:0xf bank_mask:0xf
    v_and_b32_dpp v18, v32, v10 row_newbcast:3 row_mask:0xf bank_mask:0xf
    v_and_b32_dpp v19, v32, v11 row_newbcast:3 row_mask:0xf bank_mask:0xf
    s_nop 1
    v_mfma_f32_16x16x32_bf16 v[20:23], v[16:19], v[96:99], v[20:23]
    s_mov_b32 s88, 1048576
L_cntlp_4:
    v_cmp_gt_u32 vcc, 8, v220
    s_cbranch_vccz L_cntok_3
    s_sub_u32 s88, s88, 1
    s_cbranch_scc1 L_cntok_3
    buffer_load_dwordx2 v[220:221], v242, s[76:79], 0 offen sc1
    s_waitcnt vmcnt(0)
    s_branch L_cntlp_4
L_cntok_3:
    v_cmp_eq_u32 vcc, s28, v221
    s_and_b32 s88, s2, 7
    s_lshl_b32 s89, 0x01010101, s88
    s_and_b32 s88, vcc_lo, s89
    s_cmp_eq_u32 s88, s89
    s_cselect_b32 s28, 1, 0
    v_and_b32 v242, 7, v1
    v_lshlrev_b32 v242, 3, v242
    s_waitcnt vmcnt(11)
    buffer_load_dwordx4 v[72:75], v5, s[44:47], s5 offen offset:1024 nt
    buffer_load_dwordx4 a[244:247], v250, s[52:55], s7 offen offset:256
    v_and_b32_dpp v12, v32, v8 row_newbcast:4 row_mask:0xf bank_mask:0xf
    v_and_b32_dpp v13, v32, v9 row_newbcast:4 row_mask:0xf bank_mask:0xf
    v_and_b32_dpp v14, v32, v10 row_newbcast:4 row_mask:0xf bank_mask:0xf
    v_and_b32_dpp v15, v32, v11 row_newbcast:4 row_mask:0xf bank_mask:0xf
    s_nop 1
    v_mfma_f32_16x16x32_bf16 v[20:23], v[12:15], v[100:103], v[20:23]
    s_waitcnt vmcnt(11)
    buffer_load_dwordx4 v[76:79], v5, s[44:47], s5 offen offset:2048 nt
    v_and_b32_dpp v16, v32, v8 row_newbcast:5 row_mask:0xf bank_mask:0xf
    v_and_b32_dpp v17, v32, v9 row_newbcast:5 row_mask:0xf bank_mask:0xf
    v_and_b32_dpp v18, v32, v10 row_newbcast:5 row_mask:0xf bank_mask:0xf
    v_and_b32_dpp v19, v32, v11 row_newbcast:5 row_mask:0xf bank_mask:0xf
    s_nop 1
    v_mfma_f32_16x16x32_bf16 v[20:23], v[16:19], v[104:107], v[20:23]
    s_waitcnt vmcnt(11)
    buffer_load_dwordx4 v[80:83], v5, s[44:47], s5 offen offset:3072 nt
    s_add_u32 s5, s5, 0x8000
    v_and_b32_dpp v12, v32, v8 row_newbcast:6 row_mask:0xf bank_mask:0xf
    v_and_b32_dpp v13, v32, v9 row_newbcast:6 row_mask:0xf bank_mask:0xf
    v_and_b32_dpp v14, v32, v10 row_newbcast:6 row_mask:0xf bank_mask:0xf
    v_and_b32_dpp v15, v32, v11 row_newbcast:6 row_mask:0xf bank_mask:0xf
    s_nop 1
    v_mfma_f32_16x16x32_bf16 v[20:23], v[12:15], v[108:111], v[20:23]
    s_waitcnt lgkmcnt(0)
    s_barrier
    ds_read_b64 v[218:219], v242 offset:15360
    s_lshl_b32 s95, s11, 6
    s_add_u32 s95, s95, 524288
    s_lshl_b32 s89, s10, 5
    s_add_u32 s89, s89, s95
    s_cmp_eq_u32 s3, 0
    s_cselect_b32 s89, s89, 2147479536
    s_mov_b64 exec, 15
    s_waitcnt lgkmcnt(0)
    buffer_store_dwordx2 v[218:219], v242, s[80:83], s89 offen sc1
    s_mov_b64 exec, -1
    s_waitcnt vmcnt(12)
    buffer_load_dwordx4 v[84:87], v5, s[44:47], s5 offen offset:0 nt
    buffer_load_dwordx4 a[248:251], v7, s[52:55], s7 offen offset:512
    v_and_b32_dpp v16, v32, v8 row_newbcast:7 row_mask:0xf bank_mask:0xf
    v_and_b32_dpp v17, v32, v9 row_newbcast:7 row_mask:0xf bank_mask:0xf
    v_and_b32_dpp v18, v32, v10 row_newbcast:7 row_mask:0xf bank_mask:0xf
    v_and_b32_dpp v19, v32, v11 row_newbcast:7 row_mask:0xf bank_mask:0xf
    s_nop 1
    v_mfma_f32_16x16x32_bf16 v[20:23], v[16:19], v[112:115], v[20:23]
    s_waitcnt vmcnt(12)
    buffer_load_dwordx4 v[88:91], v5, s[44:47], s5 offen offset:1024 nt
    v_and_b32_dpp v12, v32, v8 row_newbcast:8 row_mask:0xf bank_mask:0xf
    v_and_b32_dpp v13, v32, v9 row_newbcast:8 row_mask:0xf bank_mask:0xf
    v_and_b32_dpp v14, v32, v10 row_newbcast:8 row_mask:0xf bank_mask:0xf
    v_and_b32_dpp v15, v32, v11 row_newbcast:8 row_mask:0xf bank_mask:0xf
    s_nop 1
    v_mfma_f32_16x16x32_bf16 v[20:23], v[12:15], v[116:119], v[20:23]
    s_waitcnt vmcnt(12)
    buffer_load_dwordx4 v[92:95], v5, s[44:47], s5 offen offset:2048 nt
    v_and_b32_dpp v16, v32, v8 row_newbcast:9 row_mask:0xf bank_mask:0xf
    v_and_b32_dpp v17, v32, v9 row_newbcast:9 row_mask:0xf bank_mask:0xf
    v_and_b32_dpp v18, v32, v10 row_newbcast:9 row_mask:0xf bank_mask:0xf
    v_and_b32_dpp v19, v32, v11 row_newbcast:9 row_mask:0xf bank_mask:0xf
    s_nop 1
    v_mfma_f32_16x16x32_bf16 v[20:23], v[16:19], v[120:123], v[20:23]
    s_waitcnt vmcnt(12)
    buffer_load_dwordx4 v[96:99], v5, s[44:47], s5 offen offset:3072 nt
    s_add_u32 s5, s5, 0x8000
    buffer_load_dwordx4 a[252:255], v250, s[52:55], s7 offen offset:512
    v_and_b32_dpp v12, v32, v8 row_newbcast:10 row_mask:0xf bank_mask:0xf
    v_and_b32_dpp v13, v32, v9 row_newbcast:10 row_mask:0xf bank_mask:0xf
    v_and_b32_dpp v14, v32, v10 row_newbcast:10 row_mask:0xf bank_mask:0xf
    v_and_b32_dpp v15, v32, v11 row_newbcast:10 row_mask:0xf bank_mask:0xf
    s_nop 1
    v_mfma_f32_16x16x32_bf16 v[20:23], v[12:15], v[124:127], v[20:23]
    s_waitcnt vmcnt(12)
    buffer_load_dwordx4 v[100:103], v5, s[44:47], s5 offen offset:0 nt
    v_and_b32_dpp v16, v32, v8 row_newbcast:11 row_mask:0xf bank_mask:0xf
    v_and_b32_dpp v17, v32, v9 row_newbcast:11 row_mask:0xf bank_mask:0xf
    v_and_b32_dpp v18, v32, v10 row_newbcast:11 row_mask:0xf bank_mask:0xf
    v_and_b32_dpp v19, v32, v11 row_newbcast:11 row_mask:0xf bank_mask:0xf
    s_nop 1
    v_mfma_f32_16x16x32_bf16 v[20:23], v[16:19], v[64:67], v[20:23]
    s_waitcnt vmcnt(12)
    buffer_load_dwordx4 v[104:107], v5, s[44:47], s5 offen offset:1024 nt
    v_and_b32_dpp v12, v32, v8 row_newbcast:12 row_mask:0xf bank_mask:0xf
    v_and_b32_dpp v13, v32, v9 row_newbcast:12 row_mask:0xf bank_mask:0xf
    v_and_b32_dpp v14, v32, v10 row_newbcast:12 row_mask:0xf bank_mask:0xf
    v_and_b32_dpp v15, v32, v11 row_newbcast:12 row_mask:0xf bank_mask:0xf
    s_nop 1
    v_mfma_f32_16x16x32_bf16 v[20:23], v[12:15], v[68:71], v[20:23]
    s_waitcnt vmcnt(12)
    buffer_load_dwordx4 v[108:111], v5, s[44:47], s5 offen offset:2048 nt
    buffer_load_dwordx4 a[0:3], v7, s[52:55], s7 offen offset:768
    v_and_b32_dpp v16, v32, v8 row_newbcast:13 row_mask:0xf bank_mask:0xf
    v_and_b32_dpp v17, v32, v9 row_newbcast:13 row_mask:0xf bank_mask:0xf
    v_and_b32_dpp v18, v32, v10 row_newbcast:13 row_mask:0xf bank_mask:0xf
    v_and_b32_dpp v19, v32, v11 row_newbcast:13 row_mask:0xf bank_mask:0xf
    s_nop 1
    v_mfma_f32_16x16x32_bf16 v[20:23], v[16:19], v[72:75], v[20:23]
    s_waitcnt vmcnt(12)
    buffer_load_dwordx4 v[112:115], v5, s[44:47], s5 offen offset:3072 nt
    s_add_u32 s5, s5, 0x8000
    v_and_b32_dpp v12, v32, v8 row_newbcast:14 row_mask:0xf bank_mask:0xf
    v_and_b32_dpp v13, v32, v9 row_newbcast:14 row_mask:0xf bank_mask:0xf
    v_and_b32_dpp v14, v32, v10 row_newbcast:14 row_mask:0xf bank_mask:0xf
    v_and_b32_dpp v15, v32, v11 row_newbcast:14 row_mask:0xf bank_mask:0xf
    s_nop 1
    v_mfma_f32_16x16x32_bf16 v[20:23], v[12:15], v[76:79], v[20:23]
    s_waitcnt vmcnt(12)
    buffer_load_dwordx4 v[116:119], v5, s[44:47], s5 offen offset:0 nt
    v_and_b32_dpp v16, v32, v8 row_newbcast:15 row_mask:0xf bank_mask:0xf
    v_and_b32_dpp v17, v32, v9 row_newbcast:15 row_mask:0xf bank_mask:0xf
    v_and_b32_dpp v18, v32, v10 row_newbcast:15 row_mask:0xf bank_mask:0xf
    v_and_b32_dpp v19, v32, v11 row_newbcast:15 row_mask:0xf bank_mask:0xf
    s_nop 1
    v_mfma_f32_16x16x32_bf16 v[20:23], v[16:19], v[80:83], v[20:23]
    s_waitcnt vmcnt(11)
    buffer_load_dwordx4 v[120:123], v5, s[44:47], s5 offen offset:1024 nt
    buffer_load_dwordx4 a[4:7], v250, s[52:55], s7 offen offset:768
    v_and_b32_dpp v12, v33, v8 row_newbcast:0 row_mask:0xf bank_mask:0xf
    v_and_b32_dpp v13, v33, v9 row_newbcast:0 row_mask:0xf bank_mask:0xf
    v_and_b32_dpp v14, v33, v10 row_newbcast:0 row_mask:0xf bank_mask:0xf
    v_and_b32_dpp v15, v33, v11 row_newbcast:0 row_mask:0xf bank_mask:0xf
    s_nop 1
    v_mfma_f32_16x16x32_bf16 v[20:23], v[12:15], v[84:87], v[20:23]
    v_and_b32 v43, 3, v2
    v_mul_u32_u24 v251, 0x5555, v43
    v_and_b32 v43, 4, v2
    v_cmp_eq_u32 vcc, 0, v43
    v_mov_b32 v44, 0xffff
    v_mov_b32 v192, 0
    v_mov_b32 v193, 0
    v_mov_b32 v194, 0
    v_mov_b32 v195, 0
    v_mov_b32 v196, 0
    v_mov_b32 v197, 0
    v_mov_b32 v198, 0
    v_mov_b32 v199, 0
    v_mov_b32 v200, 0
    v_mov_b32 v201, 0
    v_mov_b32 v202, 0
    v_mov_b32 v203, 0
    v_mov_b32 v204, 0
    v_mov_b32 v205, 0
    v_mov_b32 v206, 0
    v_mov_b32 v207, 0
    v_mov_b32 v208, 0
    v_mov_b32 v209, 0
    v_mov_b32 v210, 0
    v_mov_b32 v211, 0
    v_cndmask_b32 v252, 0, v44, vcc
    v_xor_b32 v253, v252, v44
    s_waitcnt vmcnt(11)
    buffer_load_dwordx4 v[124:127], v5, s[44:47], s5 offen offset:2048 nt
    v_and_b32_dpp v16, v33, v8 row_newbcast:1 row_mask:0xf bank_mask:0xf
    v_and_b32_dpp v17, v33, v9 row_newbcast:1 row_mask:0xf bank_mask:0xf
    v_and_b32_dpp v18, v33, v10 row_newbcast:1 row_mask:0xf bank_mask:0xf
    v_and_b32_dpp v19, v33, v11 row_newbcast:1 row_mask:0xf bank_mask:0xf
    s_nop 1
    v_mfma_f32_16x16x32_bf16 v[20:23], v[16:19], v[88:91], v[20:23]
    s_waitcnt vmcnt(11)
    buffer_load_dwordx4 v[64:67], v5, s[44:47], s5 offen offset:3072 nt
    s_add_u32 s5, s5, 0x8000
    v_and_b32_dpp v12, v33, v8 row_newbcast:2 row_mask:0xf bank_mask:0xf
    v_and_b32_dpp v13, v33, v9 row_newbcast:2 row_mask:0xf bank_mask:0xf
    v_and_b32_dpp v14, v33, v10 row_newbcast:2 row_mask:0xf bank_mask:0xf
    v_and_b32_dpp v15, v33, v11 row_newbcast:2 row_mask:0xf bank_mask:0xf
    s_nop 1
    v_mfma_f32_16x16x32_bf16 v[20:23], v[12:15], v[92:95], v[20:23]
    s_waitcnt vmcnt(11)
    buffer_load_dwordx4 v[68:71], v5, s[44:47], s5 offen offset:0 nt
    buffer_load_dwordx4 a[8:11], v7, s[52:55], s7 offen offset:1024
    v_and_b32_dpp v16, v33, v8 row_newbcast:3 row_mask:0xf bank_mask:0xf
    v_and_b32_dpp v17, v33, v9 row_newbcast:3 row_mask:0xf bank_mask:0xf
    v_and_b32_dpp v18, v33, v10 row_newbcast:3 row_mask:0xf bank_mask:0xf
    v_and_b32_dpp v19, v33, v11 row_newbcast:3 row_mask:0xf bank_mask:0xf
    s_nop 1
    v_mfma_f32_16x16x32_bf16 v[20:23], v[16:19], v[96:99], v[20:23]
    s_waitcnt vmcnt(11)
    buffer_load_dwordx4 v[72:75], v5, s[44:47], s5 offen offset:1024 nt
    v_and_b32_dpp v12, v33, v8 row_newbcast:4 row_mask:0xf bank_mask:0xf
    v_and_b32_dpp v13, v33, v9 row_newbcast:4 row_mask:0xf bank_mask:0xf
    v_and_b32_dpp v14, v33, v10 row_newbcast:4 row_mask:0xf bank_mask:0xf
    v_and_b32_dpp v15, v33, v11 row_newbcast:4 row_mask:0xf bank_mask:0xf
    s_nop 1
    v_mfma_f32_16x16x32_bf16 v[20:23], v[12:15], v[100:103], v[20:23]
    s_waitcnt vmcnt(11)
    buffer_load_dwordx4 v[76:79], v5, s[44:47], s5 offen offset:2048 nt
    v_and_b32_dpp v16, v33, v8 row_newbcast:5 row_mask:0xf bank_mask:0xf
    v_and_b32_dpp v17, v33, v9 row_newbcast:5 row_mask:0xf bank_mask:0xf
    v_and_b32_dpp v18, v33, v10 row_newbcast:5 row_mask:0xf bank_mask:0xf
    v_and_b32_dpp v19, v33, v11 row_newbcast:5 row_mask:0xf bank_mask:0xf
    s_nop 1
    v_mfma_f32_16x16x32_bf16 v[20:23], v[16:19], v[104:107], v[20:23]
    s_waitcnt vmcnt(11)
    buffer_load_dwordx4 v[80:83], v5, s[44:47], s5 offen offset:3072 nt
    s_add_u32 s5, s5, 0x8000
    buffer_load_dwordx4 a[12:15], v250, s[52:55], s7 offen offset:1024
    s_add_u32 s7, s7, 10240
    v_and_b32_dpp v12, v33, v8 row_newbcast:6 row_mask:0xf bank_mask:0xf
    v_and_b32_dpp v13, v33, v9 row_newbcast:6 row_mask:0xf bank_mask:0xf
    v_and_b32_dpp v14, v33, v10 row_newbcast:6 row_mask:0xf bank_mask:0xf
    v_and_b32_dpp v15, v33, v11 row_newbcast:6 row_mask:0xf bank_mask:0xf
    s_nop 1
    v_mfma_f32_16x16x32_bf16 v[20:23], v[12:15], v[108:111], v[20:23]
    s_waitcnt vmcnt(11)
    buffer_load_dwordx4 v[84:87], v5, s[44:47], s5 offen offset:0 nt
    v_and_b32_dpp v16, v33, v8 row_newbcast:7 row_mask:0xf bank_mask:0xf
    v_and_b32_dpp v17, v33, v9 row_newbcast:7 row_mask:0xf bank_mask:0xf
    v_and_b32_dpp v18, v33, v10 row_newbcast:7 row_mask:0xf bank_mask:0xf
    v_and_b32_dpp v19, v33, v11 row_newbcast:7 row_mask:0xf bank_mask:0xf
    s_nop 1
    v_mfma_f32_16x16x32_bf16 v[20:23], v[16:19], v[112:115], v[20:23]
    s_waitcnt vmcnt(11)
    buffer_load_dwordx4 v[88:91], v5, s[44:47], s5 offen offset:1024 nt
    v_and_b32_dpp v12, v33, v8 row_newbcast:8 row_mask:0xf bank_mask:0xf
    v_and_b32_dpp v13, v33, v9 row_newbcast:8 row_mask:0xf bank_mask:0xf
    v_and_b32_dpp v14, v33, v10 row_newbcast:8 row_mask:0xf bank_mask:0xf
    v_and_b32_dpp v15, v33, v11 row_newbcast:8 row_mask:0xf bank_mask:0xf
    s_nop 1
    v_mfma_f32_16x16x32_bf16 v[20:23], v[12:15], v[116:119], v[20:23]
    s_waitcnt vmcnt(11)
    buffer_load_dwordx4 v[92:95], v5, s[44:47], s5 offen offset:2048 nt
    buffer_load_dwordx4 a[16:19], v7, s[52:55], s7 offen offset:0
    v_and_b32_dpp v16, v33, v8 row_newbcast:9 row_mask:0xf bank_mask:0xf
    v_and_b32_dpp v17, v33, v9 row_newbcast:9 row_mask:0xf bank_mask:0xf
    v_and_b32_dpp v18, v33, v10 row_newbcast:9 row_mask:0xf bank_mask:0xf
    v_and_b32_dpp v19, v33, v11 row_newbcast:9 row_mask:0xf bank_mask:0xf
    s_nop 1
    v_mfma_f32_16x16x32_bf16 v[20:23], v[16:19], v[120:123], v[20:23]
    s_waitcnt vmcnt(11)
    buffer_load_dwordx4 v[96:99], v5, s[44:47], s5 offen offset:3072 nt
    s_add_u32 s5, s5, 0x8000
    v_and_b32_dpp v12, v33, v8 row_newbcast:10 row_mask:0xf bank_mask:0xf
    v_and_b32_dpp v13, v33, v9 row_newbcast:10 row_mask:0xf bank_mask:0xf
    v_and_b32_dpp v14, v33, v10 row_newbcast:10 row_mask:0xf bank_mask:0xf
    v_and_b32_dpp v15, v33, v11 row_newbcast:10 row_mask:0xf bank_mask:0xf
    s_nop 1
    v_mfma_f32_16x16x32_bf16 v[20:23], v[12:15], v[124:127], v[20:23]
    s_waitcnt vmcnt(11)
    buffer_load_dwordx4 v[100:103], v5, s[44:47], s5 offen offset:0 nt
    v_and_b32_dpp v16, v33, v8 row_newbcast:11 row_mask:0xf bank_mask:0xf
    v_and_b32_dpp v17, v33, v9 row_newbcast:11 row_mask:0xf bank_mask:0xf
    v_and_b32_dpp v18, v33, v10 row_newbcast:11 row_mask:0xf bank_mask:0xf
    v_and_b32_dpp v19, v33, v11 row_newbcast:11 row_mask:0xf bank_mask:0xf
    s_nop 1
    v_mfma_f32_16x16x32_bf16 v[20:23], v[16:19], v[64:67], v[20:23]
    s_waitcnt vmcnt(11)
    buffer_load_dwordx4 v[104:107], v5, s[44:47], s5 offen offset:1024 nt
    buffer_load_dwordx4 a[20:23], v250, s[52:55], s7 offen offset:0
    v_and_b32_dpp v12, v33, v8 row_newbcast:12 row_mask:0xf bank_mask:0xf
    v_and_b32_dpp v13, v33, v9 row_newbcast:12 row_mask:0xf bank_mask:0xf
    v_and_b32_dpp v14, v33, v10 row_newbcast:12 row_mask:0xf bank_mask:0xf
    v_and_b32_dpp v15, v33, v11 row_newbcast:12 row_mask:0xf bank_mask:0xf
    s_nop 1
    v_mfma_f32_16x16x32_bf16 v[20:23], v[12:15], v[68:71], v[20:23]
    buffer_load_dwordx2 v[218:219], v242, s[80:83], s95 offen sc1
    s_waitcnt vmcnt(12)
    buffer_load_dwordx4 v[108:111], v5, s[44:47], s5 offen offset:2048 nt
    v_and_b32_dpp v16, v33, v8 row_newbcast:13 row_mask:0xf bank_mask:0xf
    v_and_b32_dpp v17, v33, v9 row_newbcast:13 row_mask:0xf bank_mask:0xf
    v_and_b32_dpp v18, v33, v10 row_newbcast:13 row_mask:0xf bank_mask:0xf
    v_and_b32_dpp v19, v33, v11 row_newbcast:13 row_mask:0xf bank_mask:0xf
    s_nop 1
    v_mfma_f32_16x16x32_bf16 v[20:23], v[16:19], v[72:75], v[20:23]
    s_waitcnt vmcnt(12)
    buffer_load_dwordx4 v[112:115], v5, s[44:47], s5 offen offset:3072 nt
    s_add_u32 s5, s5, 0x8000
    v_and_b32_dpp v12, v33, v8 row_newbcast:14 row_mask:0xf bank_mask:0xf
    v_and_b32_dpp v13, v33, v9 row_newbcast:14 row_mask:0xf bank_mask:0xf
    v_and_b32_dpp v14, v33, v10 row_newbcast:14 row_mask:0xf bank_mask:0xf
    v_and_b32_dpp v15, v33, v11 row_newbcast:14 row_mask:0xf bank_mask:0xf
    s_nop 1
    v_mfma_f32_16x16x32_bf16 v[20:23], v[12:15], v[76:79], v[20:23]
    s_waitcnt vmcnt(12)
    buffer_load_dwordx4 v[116:119], v5, s[44:47], s5 offen offset:0 nt
    buffer_load_dwordx4 a[24:27], v7, s[52:55], s7 offen offset:256
    v_and_b32_dpp v16, v33, v8 row_newbcast:15 row_mask:0xf bank_mask:0xf
    v_and_b32_dpp v17, v33, v9 row_newbcast:15 row_mask:0xf bank_mask:0xf
    v_and_b32_dpp v18, v33, v10 row_newbcast:15 row_mask:0xf bank_mask:0xf
    v_and_b32_dpp v19, v33, v11 row_newbcast:15 row_mask:0xf bank_mask:0xf
    s_nop 1
    v_mfma_f32_16x16x32_bf16 v[20:23], v[16:19], v[80:83], v[20:23]
    s_waitcnt vmcnt(12)
    buffer_load_dwordx4 v[120:123], v5, s[44:47], s5 offen offset:1024 nt
    v_and_b32_dpp v12, v34, v8 row_newbcast:0 row_mask:0xf bank_mask:0xf
    v_and_b32_dpp v13, v34, v9 row_newbcast:0 row_mask:0xf bank_mask:0xf
    v_and_b32_dpp v14, v34, v10 row_newbcast:0 row_mask:0xf bank_mask:0xf
    v_and_b32_dpp v15, v34, v11 row_newbcast:0 row_mask:0xf bank_mask:0xf
    s_nop 1
    v_mfma_f32_16x16x32_bf16 v[20:23], v[12:15], v[84:87], v[20:23]
    s_waitcnt vmcnt(12)
    buffer_load_dwordx4 v[124:127], v5, s[44:47], s5 offen offset:2048 nt
    v_and_b32_dpp v16, v34, v8 row_newbcast:1 row_mask:0xf bank_mask:0xf
    v_and_b32_dpp v17, v34, v9 row_newbcast:1 row_mask:0xf bank_mask:0xf
    v_and_b32_dpp v18, v34, v10 row_newbcast:1 row_mask:0xf bank_mask:0xf
    v_and_b32_dpp v19, v34, v11 row_newbcast:1 row_mask:0xf bank_mask:0xf
    s_nop 1
    v_mfma_f32_16x16x32_bf16 v[20:23], v[16:19], v[88:91], v[20:23]
    s_waitcnt vmcnt(12)
    buffer_load_dwordx4 v[64:67], v5, s[44:47], s5 offen offset:3072 nt
    s_add_u32 s5, s5, 0x8000
    buffer_load_dwordx4 a[28:31], v250, s[52:55], s7 offen offset:256
    v_and_b32_dpp v12, v34, v8 row_newbcast:2 row_mask:0xf bank_mask:0xf
    v_and_b32_dpp v13, v34, v9 row_newbcast:2 row_mask:0xf bank_mask:0xf
    v_and_b32_dpp v14, v34, v10 row_newbcast:2 row_mask:0xf bank_mask:0xf
    v_and_b32_dpp v15, v34, v11 row_newbcast:2 row_mask:0xf bank_mask:0xf
    s_nop 1
    v_mfma_f32_16x16x32_bf16 v[20:23], v[12:15], v[92:95], v[20:23]
    s_waitcnt vmcnt(12)
    buffer_load_dwordx4 v[68:71], v5, s[44:47], s5 offen offset:0 nt
    v_and_b32_dpp v16, v34, v8 row_newbcast:3 row_mask:0xf bank_mask:0xf
    v_and_b32_dpp v17, v34, v9 row_newbcast:3 row_mask:0xf bank_mask:0xf
    v_and_b32_dpp v18, v34, v10 row_newbcast:3 row_mask:0xf bank_mask:0xf
    v_and_b32_dpp v19, v34, v11 row_newbcast:3 row_mask:0xf bank_mask:0xf
    s_nop 1
    v_mfma_f32_16x16x32_bf16 v[20:23], v[16:19], v[96:99], v[20:23]
    s_waitcnt vmcnt(12)
    buffer_load_dwordx4 v[72:75], v5, s[44:47], s5 offen offset:1024 nt
    v_and_b32_dpp v12, v34, v8 row_newbcast:4 row_mask:0xf bank_mask:0xf
    v_and_b32_dpp v13, v34, v9 row_newbcast:4 row_mask:0xf bank_mask:0xf
    v_and_b32_dpp v14, v34, v10 row_newbcast:4 row_mask:0xf bank_mask:0xf
    v_and_b32_dpp v15, v34, v11 row_newbcast:4 row_mask:0xf bank_mask:0xf
    s_nop 1
    v_mfma_f32_16x16x32_bf16 v[20:23], v[12:15], v[100:103], v[20:23]
    s_waitcnt vmcnt(12)
    buffer_load_dwordx4 v[76:79], v5, s[44:47], s5 offen offset:2048 nt
    buffer_load_dwordx4 a[32:35], v7, s[52:55], s7 offen offset:512
    v_and_b32_dpp v16, v34, v8 row_newbcast:5 row_mask:0xf bank_mask:0xf
    v_and_b32_dpp v17, v34, v9 row_newbcast:5 row_mask:0xf bank_mask:0xf
    v_and_b32_dpp v18, v34, v10 row_newbcast:5 row_mask:0xf bank_mask:0xf
    v_and_b32_dpp v19, v34, v11 row_newbcast:5 row_mask:0xf bank_mask:0xf
    s_nop 1
    v_mfma_f32_16x16x32_bf16 v[20:23], v[16:19], v[104:107], v[20:23]
    s_waitcnt vmcnt(11)
    buffer_load_dwordx4 v[80:83], v5, s[44:47], s5 offen offset:3072 nt
    s_add_u32 s5, s5, 0x8000
    v_and_b32_dpp v12, v34, v8 row_newbcast:6 row_mask:0xf bank_mask:0xf
    v_and_b32_dpp v13, v34, v9 row_newbcast:6 row_mask:0xf bank_mask:0xf
    v_and_b32_dpp v14, v34, v10 row_newbcast:6 row_mask:0xf bank_mask:0xf
    v_and_b32_dpp v15, v34, v11 row_newbcast:6 row_mask:0xf bank_mask:0xf
    s_nop 1
    v_mfma_f32_16x16x32_bf16 v[20:23], v[12:15], v[108:111], v[20:23]
    s_waitcnt vmcnt(11)
    buffer_load_dwordx4 v[84:87], v5, s[44:47], s5 offen offset:0 nt
    v_and_b32_dpp v16, v34, v8 row_newbcast:7 row_mask:0xf bank_mask:0xf
    v_and_b32_dpp v17, v34, v9 row_newbcast:7 row_mask:0xf bank_mask:0xf
    v_and_b32_dpp v18, v34, v10 row_newbcast:7 row_mask:0xf bank_mask:0xf
    v_and_b32_dpp v19, v34, v11 row_newbcast:7 row_mask:0xf bank_mask:0xf
    s_nop 1
    v_mfma_f32_16x16x32_bf16 v[20:23], v[16:19], v[112:115], v[20:23]
    s_waitcnt vmcnt(11)
    buffer_load_dwordx4 v[88:91], v5, s[44:47], s5 offen offset:1024 nt
    buffer_load_dwordx4 a[36:39], v250, s[52:55], s7 offen offset:512
    v_and_b32_dpp v12, v34, v8 row_newbcast:8 row_mask:0xf bank_mask:0xf
    v_and_b32_dpp v13, v34, v9 row_newbcast:8 row_mask:0xf bank_mask:0xf
    v_and_b32_dpp v14, v34, v10 row_newbcast:8 row_mask:0xf bank_mask:0xf
    v_and_b32_dpp v15, v34, v11 row_newbcast:8 row_mask:0xf bank_mask:0xf
    s_nop 1
    v_mfma_f32_16x16x32_bf16 v[20:23], v[12:15], v[116:119], v[20:23]
    s_mov_b32 s88, 1048576
L_mllp_6:
    v_max_u32 v40, v218, v219
    v_cmp_eq_u32 vcc, -1, v40
    s_cbranch_vccz L_mlok_5
    s_sub_u32 s88, s88, 1
    s_cbranch_scc1 L_mlok_5
    buffer_load_dwordx2 v[218:219], v242, s[80:83], s95 offen sc1
    s_waitcnt vmcnt(0)
    s_branch L_mllp_6
L_mlok_5:
    v_max_f32_dpp v40, v218, v218 quad_perm:[1,0,3,2] row_mask:0xf bank_mask:0xf
    s_nop 1
    v_max_f32_dpp v40, v40, v40 quad_perm:[2,3,0,1] row_mask:0xf bank_mask:0xf
    s_nop 1
    v_max_f32_dpp v40, v40, v40 row_half_mirror row_mask:0xf bank_mask:0xf
    v_sub_f32 v41, v218, v40
    v_mul_f32 v41, 0x3fb8aa3b, v41
    v_exp_f32 v41, v41
    s_nop 0
    v_mul_f32 v42, v41, v219
    s_nop 1
    v_add_f32_dpp v42, v42, v42 quad_perm:[1,0,3,2] row_mask:0xf bank_mask:0xf
    s_nop 1
    v_add_f32_dpp v42, v42, v42 quad_perm:[2,3,0,1] row_mask:0xf bank_mask:0xf
    s_nop 1
    v_add_f32_dpp v42, v42, v42 row_half_mirror row_mask:0xf bank_mask:0xf
    v_rcp_f32 v42, v42
    s_lshl_b32 s92, s10, 2
    v_mul_f32 v41, v41, v42
    s_add_u32 s93, s92, 1
    s_add_u32 s94, s92, 2
    s_add_u32 s95, s92, 3
    v_readlane_b32 s16, v41, s92
    v_readlane_b32 s17, v41, s93
    v_readlane_b32 s18, v41, s94
    v_readlane_b32 s19, v41, s95
    s_waitcnt vmcnt(11)
    buffer_load_dwordx4 v[92:95], v5, s[44:47], s5 offen offset:2048 nt
    v_and_b32_dpp v16, v34, v8 row_newbcast:9 row_mask:0xf bank_mask:0xf
    v_and_b32_dpp v17, v34, v9 row_newbcast:9 row_mask:0xf bank_mask:0xf
    v_and_b32_dpp v18, v34, v10 row_newbcast:9 row_mask:0xf bank_mask:0xf
    v_and_b32_dpp v19, v34, v11 row_newbcast:9 row_mask:0xf bank_mask:0xf
    s_nop 1
    v_mfma_f32_16x16x32_bf16 v[20:23], v[16:19], v[120:123], v[20:23]
    s_waitcnt vmcnt(11)
    buffer_load_dwordx4 v[96:99], v5, s[44:47], s5 offen offset:3072 nt
    s_add_u32 s5, s5, 0x8000
    v_and_b32_dpp v12, v34, v8 row_newbcast:10 row_mask:0xf bank_mask:0xf
    v_and_b32_dpp v13, v34, v9 row_newbcast:10 row_mask:0xf bank_mask:0xf
    v_and_b32_dpp v14, v34, v10 row_newbcast:10 row_mask:0xf bank_mask:0xf
    v_and_b32_dpp v15, v34, v11 row_newbcast:10 row_mask:0xf bank_mask:0xf
    s_nop 1
    v_mfma_f32_16x16x32_bf16 v[20:23], v[12:15], v[124:127], v[20:23]
    s_waitcnt vmcnt(11)
    buffer_load_dwordx4 v[100:103], v5, s[44:47], s5 offen offset:0 nt
    buffer_load_dwordx4 a[40:43], v7, s[52:55], s7 offen offset:768
    v_and_b32_dpp v16, v34, v8 row_newbcast:11 row_mask:0xf bank_mask:0xf
    v_and_b32_dpp v17, v34, v9 row_newbcast:11 row_mask:0xf bank_mask:0xf
    v_and_b32_dpp v18, v34, v10 row_newbcast:11 row_mask:0xf bank_mask:0xf
    v_and_b32_dpp v19, v34, v11 row_newbcast:11 row_mask:0xf bank_mask:0xf
    s_nop 1
    v_mfma_f32_16x16x32_bf16 v[20:23], v[16:19], v[64:67], v[20:23]
    s_waitcnt vmcnt(11)
    buffer_load_dwordx4 v[104:107], v5, s[44:47], s5 offen offset:1024 nt
    v_and_b32_dpp v12, v34, v8 row_newbcast:12 row_mask:0xf bank_mask:0xf
    v_and_b32_dpp v13, v34, v9 row_newbcast:12 row_mask:0xf bank_mask:0xf
    v_and_b32_dpp v14, v34, v10 row_newbcast:12 row_mask:0xf bank_mask:0xf
    v_and_b32_dpp v15, v34, v11 row_newbcast:12 row_mask:0xf bank_mask:0xf
    s_nop 1
    v_mfma_f32_16x16x32_bf16 v[20:23], v[12:15], v[68:71], v[20:23]
    s_and_b32 s88, s2, 7
    s_mov_b32 s89, s31
    s_cmp_ge_u32 s89, 10
    s_cselect_b32 s90, 10, 0
    s_addc_u32 s14, s88, s88
    s_sub_u32 s13, s89, s90
    s_lshl_b32 s12, s88, 3
    s_add_u32 s12, s12, s89
    s_sub_u32 s12, s12, 20
    s_cmp_lt_u32 s12, 54
    s_cselect_b32 s15, 2, 0
    s_cmp_lt_u32 s89, 28
    s_cselect_b32 s15, s15, 0
    s_cmp_lt_u32 s89, 20
    s_cselect_b32 s15, 1, s15
    s_cmp_lt_u32 s88, 7
    s_cselect_b32 s15, s15, 0
    s_cmp_ge_u32 s89, 28
    s_cselect_b32 s15, 3, s15
    s_cmp_eq_u32 s15, 1
    s_cselect_b64 s[60:61], s[60:61], s[32:33]
    s_cselect_b64 s[64:65], s[64:65], s[32:33]
    s_mov_b32 s69, 256
    s_cselect_b32 s68, 13824, s69
    s_cselect_b32 s69, 0x10000000, s69
    s_sub_u32 s90, s15, 1
    s_cmp_lt_u32 s90, 2
    s_cselect_b32 s62, 2211840, 0
    s_mov_b32 s63, 0x00020000
    s_mov_b32 s66, s62
    s_mov_b32 s67, 0x00020000
    s_mul_i32 s20, s3, 1280
    s_lshl_b32 s88, s13, 7
    s_add_u32 s20, s20, s88
    buffer_load_dwordx2 v[222:223], v237, s[56:59], s20 offen
    s_waitcnt vmcnt(12)
    buffer_load_dwordx4 v[108:111], v5, s[44:47], s5 offen offset:2048 nt
    v_and_b32_dpp v16, v34, v8 row_newbcast:13 row_mask:0xf bank_mask:0xf
    v_and_b32_dpp v17, v34, v9 row_newbcast:13 row_mask:0xf bank_mask:0xf
    v_and_b32_dpp v18, v34, v10 row_newbcast:13 row_mask:0xf bank_mask:0xf
    v_and_b32_dpp v19, v34, v11 row_newbcast:13 row_mask:0xf bank_mask:0xf
    s_nop 1
    v_mfma_f32_16x16x32_bf16 v[20:23], v[16:19], v[72:75], v[20:23]
    s_waitcnt vmcnt(12)
    buffer_load_dwordx4 v[112:115], v5, s[44:47], s5 offen offset:3072 nt
    s_add_u32 s5, s5, 0x8000
    buffer_load_dwordx4 a[44:47], v250, s[52:55], s7 offen offset:768
    v_and_b32_dpp v12, v34, v8 row_newbcast:14 row_mask:0xf bank_mask:0xf
    v_and_b32_dpp v13, v34, v9 row_newbcast:14 row_mask:0xf bank_mask:0xf
    v_and_b32_dpp v14, v34, v10 row_newbcast:14 row_mask:0xf bank_mask:0xf
    v_and_b32_dpp v15, v34, v11 row_newbcast:14 row_mask:0xf bank_mask:0xf
    s_nop 1
    v_mfma_f32_16x16x32_bf16 v[20:23], v[12:15], v[76:79], v[20:23]
    v_bfe_u32 v43, v2, 1, 2
    v_lshlrev_b32 v43, 5, v43
    v_lshl_add_u32 v43, v3, 3, v43
    v_and_b32 v44, 1, v2
    v_lshl_add_u32 v43, v44, 2, v43
    s_lshl_b32 s92, s3, 7
    v_add_u32 v238, s92, v43
    s_mul_i32 s92, s3, 144
    v_add_u32 v246, s92, v237
    v_lshlrev_b32 v43, 5, v2
    v_lshl_add_u32 v43, v3, 4, v43
    s_mul_i32 s92, s3, 2560
    v_add_u32 v239, s92, v43
    s_and_b32 s93, s2, 7
    s_mul_i32 s92, s93, 40960
    s_add_u32 s92, s92, 552960
    s_lshl_b32 s94, s3, 2
    s_add_u32 s94, s94, s31
    s_sub_u32 s94, s94, 28
    s_lshl_b32 s22, s94, 10
    s_add_u32 s22, s22, s92
    s_lshl_b32 s23, s94, 11
    s_lshl_b32 s93, s93, 8
    s_add_u32 s23, s23, s93
    s_add_u32 s23, s23, 880640
    s_lshl_b32 s93, s9, 10
    s_add_u32 s92, s92, s93
    s_lshr_b32 s93, s2, 6
    s_lshl_b32 s93, s93, 1
    s_add_u32 s93, s93, s10
    s_lshl_b32 s93, s93, 7
    s_add_u32 s92, s92, s93
    v_lshrrev_b32 v43, 4, v0
    v_lshlrev_b32 v236, 12, v43
    v_lshlrev_b32 v44, 3, v2
    v_cmp_gt_u32 vcc, 160, v0
    v_add3_u32 v236, v236, v44, s92
    v_mov_b32 v41, 2147483632
    v_cndmask_b32 v236, v41, v236, vcc
    v_lshlrev_b32 v44, 4, v2
    s_mov_b32 s93, 1280
    s_cmp_eq_u32 s15, 1
    s_cselect_b32 s92, 3456, s93
    v_mad_u32_u24 v240, v3, s92, v44
    s_mov_b32 s92, 272
    v_mad_u32_u24 v241, v3, s92, v44
    s_mul_i32 s92, s3, 10880
    v_add_u32 v241, s92, v241
    s_lshl_b32 s92, s13, 2
    s_add_u32 s92, s92, s3
    s_lshl_b32 s24, s92, 11
    s_add_u32 s24, s24, 880640
    s_mul_i32 s26, s92, 6912
    s_add_u32 s26, s26, 962560
    s_add_u32 s27, s26, 4096
    s_mul_i32 s4, s92, 55296
    s_lshl_b32 s92, s14, 8
    s_add_u32 s4, s4, s92
    s_lshl_b32 s92, s12, 2
    s_add_u32 s92, s92, s3
    s_mul_i32 s6, s92, 10240
    s_add_u32 s92, s6, 5120
    s_cmp_eq_u32 s15, 1
    s_cselect_b32 s6, s4, s6
    s_cselect_b32 s4, s4, s92
    s_mov_b32 s25, s6
    s_cmp_eq_u32 s15, 2
    s_cselect_b32 s32, s6, 2146435056
    s_add_u32 s33, s32, 5120
    s_waitcnt vmcnt(12)
    buffer_load_dwordx4 v[116:119], v5, s[44:47], s5 offen offset:0 nt
    v_and_b32_dpp v16, v34, v8 row_newbcast:15 row_mask:0xf bank_mask:0xf
    v_and_b32_dpp v17, v34, v9 row_newbcast:15 row_mask:0xf bank_mask:0xf
    v_and_b32_dpp v18, v34, v10 row_newbcast:15 row_mask:0xf bank_mask:0xf
    v_and_b32_dpp v19, v34, v11 row_newbcast:15 row_mask:0xf bank_mask:0xf
    s_nop 1
    v_mfma_f32_16x16x32_bf16 v[20:23], v[16:19], v[80:83], v[20:23]
    s_waitcnt vmcnt(12)
    buffer_load_dwordx4 v[120:123], v5, s[44:47], s5 offen offset:1024 nt
    v_and_b32_dpp v12, v35, v8 row_newbcast:0 row_mask:0xf bank_mask:0xf
    v_and_b32_dpp v13, v35, v9 row_newbcast:0 row_mask:0xf bank_mask:0xf
    v_and_b32_dpp v14, v35, v10 row_newbcast:0 row_mask:0xf bank_mask:0xf
    v_and_b32_dpp v15, v35, v11 row_newbcast:0 row_mask:0xf bank_mask:0xf
    s_nop 1
    v_mfma_f32_16x16x32_bf16 v[20:23], v[12:15], v[84:87], v[20:23]
    v_and_b32 v244, 3, v2
    v_lshrrev_b32 v43, 1, v3
    v_mul_u32_u24 v43, 40, v43
    v_and_b32 v44, 1, v3
    v_lshl_add_u32 v43, v44, 3, v43
    v_add_u32 v43, v43, v243
    v_mul_u32_u24 v245, 272, v43
    v_lshl_add_u32 v245, v244, 3, v245
    s_lshl_b32 s93, s3, 6
    v_add_u32 v245, s93, v245
    v_lshlrev_b32 v249, 4, v3
    v_min_u32 v247, 4, v2
    v_mul_u32_u24 v247, 144, v247
    v_add_u32 v247, v247, v249
    v_lshl_add_u32 v248, v2, 6, v249
    v_mov_b32 v46, 0x3f803f80
    v_lshlrev_b32 v47, 2, v0
    ds_write_b32 v47, v46 offset:14336
    s_lshl_b32 s92, s14, 2
    s_add_u32 s92, s92, s3
    s_mul_i32 s71, s92, 10240
    s_lshl_b32 s93, s13, 9
    s_add_u32 s71, s71, s93
    s_lshr_b32 s29, s71, 2
    s_add_u32 s29, s29, 1239040
    s_add_u32 s71, s71, 1382400
    s_add_u32 s30, s71, 5120
    s_mul_i32 s21, s14, 10
    s_add_u32 s21, s21, s13
    s_lshl_b32 s21, s21, 7
    s_add_u32 s21, s21, 534528
    s_cmp_eq_u32 s3, 3
    s_cselect_b32 s21, s21, 2147479536
    s_mov_b32 s70, 0
    v_and_b32 v224, 0x3f803f80, v8
    v_and_b32 v225, 0x3f803f80, v9
    v_and_b32 v226, 0x3f803f80, v10
    v_and_b32 v227, 0x3f803f80, v11
    s_waitcnt vmcnt(12)
    buffer_load_dwordx4 v[124:127], v5, s[44:47], s5 offen offset:2048 nt
    buffer_load_dwordx4 a[48:51], v7, s[52:55], s7 offen offset:1024
    v_and_b32_dpp v16, v35, v8 row_newbcast:1 row_mask:0xf bank_mask:0xf
    v_and_b32_dpp v17, v35, v9 row_newbcast:1 row_mask:0xf bank_mask:0xf
    v_and_b32_dpp v18, v35, v10 row_newbcast:1 row_mask:0xf bank_mask:0xf
    v_and_b32_dpp v19, v35, v11 row_newbcast:1 row_mask:0xf bank_mask:0xf
    s_nop 1
    v_mfma_f32_16x16x32_bf16 v[20:23], v[16:19], v[88:91], v[20:23]
    s_waitcnt vmcnt(12)
    buffer_load_dwordx4 v[64:67], v5, s[44:47], s5 offen offset:3072 nt
    s_add_u32 s5, s5, 0x8000
    v_and_b32_dpp v12, v35, v8 row_newbcast:2 row_mask:0xf bank_mask:0xf
    v_and_b32_dpp v13, v35, v9 row_newbcast:2 row_mask:0xf bank_mask:0xf
    v_and_b32_dpp v14, v35, v10 row_newbcast:2 row_mask:0xf bank_mask:0xf
    v_and_b32_dpp v15, v35, v11 row_newbcast:2 row_mask:0xf bank_mask:0xf
    s_nop 1
    v_mfma_f32_16x16x32_bf16 v[20:23], v[12:15], v[92:95], v[20:23]
    v_lshrrev_b32 v43, 3, v1
    v_lshlrev_b32 v43, 14, v43
    v_and_b32 v44, 7, v1
    v_lshl_add_u32 v43, v44, 7, v43
    s_cmp_eq_u32 s15, 3
    s_cselect_b32 s92, s22, 2146435056
    s_cmp_lt_u32 s3, 2
    s_cselect_b32 s93, 0, 8
    s_lshr_b32 exec_lo, 0xffffff, s93
    s_mov_b32 exec_hi, 0
    buffer_load_dword v62, v43, s[80:83], s92 offen sc1
    s_mov_b64 exec, -1
    s_waitcnt vmcnt(13)
    buffer_load_dwordx4 v[68:71], v5, s[44:47], s5 offen offset:0 nt
    v_and_b32_dpp v16, v35, v8 row_newbcast:3 row_mask:0xf bank_mask:0xf
    v_and_b32_dpp v17, v35, v9 row_newbcast:3 row_mask:0xf bank_mask:0xf
    v_and_b32_dpp v18, v35, v10 row_newbcast:3 row_mask:0xf bank_mask:0xf
    v_and_b32_dpp v19, v35, v11 row_newbcast:3 row_mask:0xf bank_mask:0xf
    s_nop 1
    v_mfma_f32_16x16x32_bf16 v[20:23], v[16:19], v[96:99], v[20:23]
    s_waitcnt vmcnt(13)
    buffer_load_dwordx4 v[72:75], v5, s[44:47], s5 offen offset:1024 nt
    buffer_load_dwordx4 a[52:55], v250, s[52:55], s7 offen offset:1024
    s_add_u32 s7, s7, 10240
    v_and_b32_dpp v12, v35, v8 row_newbcast:4 row_mask:0xf bank_mask:0xf
    v_and_b32_dpp v13, v35, v9 row_newbcast:4 row_mask:0xf bank_mask:0xf
    v_and_b32_dpp v14, v35, v10 row_newbcast:4 row_mask:0xf bank_mask:0xf
    v_and_b32_dpp v15, v35, v11 row_newbcast:4 row_mask:0xf bank_mask:0xf
    s_nop 1
    v_mfma_f32_16x16x32_bf16 v[20:23], v[12:15], v[100:103], v[20:23]
    s_waitcnt vmcnt(13)
    buffer_load_dwordx4 v[76:79], v5, s[44:47], s5 offen offset:2048 nt
    v_and_b32_dpp v16, v35, v8 row_newbcast:5 row_mask:0xf bank_mask:0xf
    v_and_b32_dpp v17, v35, v9 row_newbcast:5 row_mask:0xf bank_mask:0xf
    v_and_b32_dpp v18, v35, v10 row_newbcast:5 row_mask:0xf bank_mask:0xf
    v_and_b32_dpp v19, v35, v11 row_newbcast:5 row_mask:0xf bank_mask:0xf
    s_nop 1
    v_mfma_f32_16x16x32_bf16 v[20:23], v[16:19], v[104:107], v[20:23]
    s_waitcnt vmcnt(12)
    buffer_load_dwordx4 v[80:83], v5, s[44:47], s5 offen offset:3072 nt
    s_add_u32 s5, s5, 0x8000
    v_and_b32_dpp v12, v35, v8 row_newbcast:6 row_mask:0xf bank_mask:0xf
    v_and_b32_dpp v13, v35, v9 row_newbcast:6 row_mask:0xf bank_mask:0xf
    v_and_b32_dpp v14, v35, v10 row_newbcast:6 row_mask:0xf bank_mask:0xf
    v_and_b32_dpp v15, v35, v11 row_newbcast:6 row_mask:0xf bank_mask:0xf
    s_nop 1
    v_mfma_f32_16x16x32_bf16 v[20:23], v[12:15], v[108:111], v[20:23]
    s_waitcnt vmcnt(12)
    v_and_b32_dpp v16, v35, v8 row_newbcast:7 row_mask:0xf bank_mask:0xf
    v_and_b32_dpp v17, v35, v9 row_newbcast:7 row_mask:0xf bank_mask:0xf
    v_and_b32_dpp v18, v35, v10 row_newbcast:7 row_mask:0xf bank_mask:0xf
    v_and_b32_dpp v19, v35, v11 row_newbcast:7 row_mask:0xf bank_mask:0xf
    s_nop 1
    v_mfma_f32_16x16x32_bf16 v[20:23], v[16:19], v[112:115], v[20:23]
    s_waitcnt vmcnt(10)
    v_and_b32_dpp v12, v35, v8 row_newbcast:8 row_mask:0xf bank_mask:0xf
    v_and_b32_dpp v13, v35, v9 row_newbcast:8 row_mask:0xf bank_mask:0xf
    v_and_b32_dpp v14, v35, v10 row_newbcast:8 row_mask:0xf bank_mask:0xf
    v_and_b32_dpp v15, v35, v11 row_newbcast:8 row_mask:0xf bank_mask:0xf
    s_nop 1
    v_mfma_f32_16x16x32_bf16 v[20:23], v[12:15], v[116:119], v[20:23]
    v_lshlrev_b32 v228, 16, v222
    v_and_b32 v229, 0xffff0000, v222
    v_lshlrev_b32 v230, 16, v223
    v_and_b32 v231, 0xffff0000, v223
    s_waitcnt vmcnt(9)
    v_and_b32_dpp v16, v35, v8 row_newbcast:9 row_mask:0xf bank_mask:0xf
    v_and_b32_dpp v17, v35, v9 row_newbcast:9 row_mask:0xf bank_mask:0xf
    v_and_b32_dpp v18, v35, v10 row_newbcast:9 row_mask:0xf bank_mask:0xf
    v_and_b32_dpp v19, v35, v11 row_newbcast:9 row_mask:0xf bank_mask:0xf
    s_nop 1
    v_mfma_f32_16x16x32_bf16 v[20:23], v[16:19], v[120:123], v[20:23]
    v_and_b32_dpp v40, v35, v8 row_newbcast:10 row_mask:0xf bank_mask:0xf
    v_and_b32_dpp v41, v35, v9 row_newbcast:10 row_mask:0xf bank_mask:0xf
    v_and_b32_dpp v42, v35, v10 row_newbcast:10 row_mask:0xf bank_mask:0xf
    v_and_b32_dpp v43, v35, v11 row_newbcast:10 row_mask:0xf bank_mask:0xf
    v_and_b32_dpp v44, v35, v8 row_newbcast:11 row_mask:0xf bank_mask:0xf
    v_and_b32_dpp v45, v35, v9 row_newbcast:11 row_mask:0xf bank_mask:0xf
    v_and_b32_dpp v46, v35, v10 row_newbcast:11 row_mask:0xf bank_mask:0xf
    v_and_b32_dpp v47, v35, v11 row_newbcast:11 row_mask:0xf bank_mask:0xf
    v_and_b32_dpp v48, v35, v8 row_newbcast:12 row_mask:0xf bank_mask:0xf
    v_and_b32_dpp v49, v35, v9 row_newbcast:12 row_mask:0xf bank_mask:0xf
    v_and_b32_dpp v50, v35, v10 row_newbcast:12 row_mask:0xf bank_mask:0xf
    v_and_b32_dpp v51, v35, v11 row_newbcast:12 row_mask:0xf bank_mask:0xf
    v_and_b32_dpp v52, v35, v8 row_newbcast:13 row_mask:0xf bank_mask:0xf
    v_and_b32_dpp v53, v35, v9 row_newbcast:13 row_mask:0xf bank_mask:0xf
    v_and_b32_dpp v54, v35, v10 row_newbcast:13 row_mask:0xf bank_mask:0xf
    v_and_b32_dpp v55, v35, v11 row_newbcast:13 row_mask:0xf bank_mask:0xf
    v_and_b32_dpp v12, v35, v8 row_newbcast:14 row_mask:0xf bank_mask:0xf
    v_and_b32_dpp v13, v35, v9 row_newbcast:14 row_mask:0xf bank_mask:0xf
    v_and_b32_dpp v14, v35, v10 row_newbcast:14 row_mask:0xf bank_mask:0xf
    v_and_b32_dpp v15, v35, v11 row_newbcast:14 row_mask:0xf bank_mask:0xf
    v_and_b32_dpp v16, v35, v8 row_newbcast:15 row_mask:0xf bank_mask:0xf
    v_and_b32_dpp v17, v35, v9 row_newbcast:15 row_mask:0xf bank_mask:0xf
    v_and_b32_dpp v18, v35, v10 row_newbcast:15 row_mask:0xf bank_mask:0xf
    v_and_b32_dpp v19, v35, v11 row_newbcast:15 row_mask:0xf bank_mask:0xf
    s_waitcnt vmcnt(8)
    v_mfma_f32_16x16x32_bf16 v[20:23], v[40:43], v[124:127], v[20:23]
    s_waitcnt vmcnt(6)
    v_mfma_f32_16x16x32_bf16 v[20:23], v[44:47], v[64:67], v[20:23]
    s_waitcnt vmcnt(4)
    v_mfma_f32_16x16x32_bf16 v[20:23], v[48:51], v[68:71], v[20:23]
    s_waitcnt vmcnt(3)
    v_mfma_f32_16x16x32_bf16 v[20:23], v[52:55], v[72:75], v[20:23]
    s_waitcnt vmcnt(1)
    v_mfma_f32_16x16x32_bf16 v[20:23], v[12:15], v[76:79], v[20:23]
    s_waitcnt vmcnt(0)
    v_mfma_f32_16x16x32_bf16 v[20:23], v[16:19], v[80:83], v[20:23]
    s_mov_b32 exec_hi, 0
    s_nop 6
    ds_write_b128 v232, v[20:23] offset:0
    s_mov_b32 exec_hi, -1
    buffer_load_dwordx4 a[56:59], v240, s[60:63], s6 offen
    s_add_u32 s6, s6, s68
    buffer_load_dwordx4 a[60:63], v240, s[60:63], s6 offen
    s_add_u32 s6, s6, s68
    buffer_load_dwordx4 a[64:67], v240, s[60:63], s6 offen
    s_add_u32 s6, s6, s68
    s_waitcnt lgkmcnt(0)
    s_barrier
    ds_read_b32 v40, v238 offset:0
    ds_read_b32 v41, v238 offset:1024
    ds_read_b32 v42, v238 offset:2048
    ds_read_b32 v43, v238 offset:3072
    s_waitcnt lgkmcnt(3)
    v_mul_f32 v40, s16, v40
    s_waitcnt lgkmcnt(2)
    v_fmac_f32 v40, s17, v41
    s_waitcnt lgkmcnt(1)
    v_fmac_f32 v40, s18, v42
    s_waitcnt lgkmcnt(0)
    v_fmac_f32 v40, s19, v43
    v_cvt_pk_bf16_f32 v40, v40, v40
    s_nop 1
    v_and_b32_dpp v12, v40, v252 row_newbcast:0 row_mask:0xf bank_mask:0xf
    v_and_b32_dpp v13, v40, v253 row_newbcast:0 row_mask:0xf bank_mask:0xf
    v_and_b32_dpp v14, v40, v252 row_newbcast:1 row_mask:0xf bank_mask:0xf
    v_and_b32_dpp v15, v40, v253 row_newbcast:1 row_mask:0xf bank_mask:0xf
    s_nop 1
    v_smfmac_f32_16x16x64_bf16 v[192:195], v[12:15], v[128:135], v251
    v_and_b32_dpp v16, v40, v252 row_newbcast:2 row_mask:0xf bank_mask:0xf
    v_and_b32_dpp v17, v40, v253 row_newbcast:2 row_mask:0xf bank_mask:0xf
    v_and_b32_dpp v18, v40, v252 row_newbcast:3 row_mask:0xf bank_mask:0xf
    v_and_b32_dpp v19, v40, v253 row_newbcast:3 row_mask:0xf bank_mask:0xf
    v_smfmac_f32_16x16x64_bf16 v[196:199], v[12:15], v[136:143], v251
    v_smfmac_f32_16x16x64_bf16 v[200:203], v[12:15], v[144:151], v251
    v_and_b32_dpp v44, v40, v252 row_newbcast:4 row_mask:0xf bank_mask:0xf
    v_and_b32_dpp v45, v40, v253 row_newbcast:4 row_mask:0xf bank_mask:0xf
    v_and_b32_dpp v46, v40, v252 row_newbcast:5 row_mask:0xf bank_mask:0xf
    v_and_b32_dpp v47, v40, v253 row_newbcast:5 row_mask:0xf bank_mask:0xf
    v_smfmac_f32_16x16x64_bf16 v[204:207], v[12:15], v[152:159], v251
    v_and_b32_dpp v48, v40, v252 row_newbcast:6 row_mask:0xf bank_mask:0xf
    v_and_b32_dpp v49, v40, v253 row_newbcast:6 row_mask:0xf bank_mask:0xf
    v_and_b32_dpp v50, v40, v252 row_newbcast:7 row_mask:0xf bank_mask:0xf
    v_and_b32_dpp v51, v40, v253 row_newbcast:7 row_mask:0xf bank_mask:0xf
    v_smfmac_f32_16x16x64_bf16 v[208:211], v[12:15], v[160:167], v251
    v_smfmac_f32_16x16x64_bf16 v[192:195], v[16:19], v[168:175], v251
    v_smfmac_f32_16x16x64_bf16 v[192:195], v[44:47], a[232:239], v251
    v_smfmac_f32_16x16x64_bf16 v[192:195], v[48:51], a[16:23], v251
    v_smfmac_f32_16x16x64_bf16 v[196:199], v[16:19], v[176:183], v251
    v_smfmac_f32_16x16x64_bf16 v[196:199], v[44:47], a[240:247], v251
    v_smfmac_f32_16x16x64_bf16 v[196:199], v[48:51], a[24:31], v251
    v_smfmac_f32_16x16x64_bf16 v[200:203], v[16:19], v[184:191], v251
    v_smfmac_f32_16x16x64_bf16 v[200:203], v[44:47], a[248:255], v251
    v_smfmac_f32_16x16x64_bf16 v[200:203], v[48:51], a[32:39], v251
    v_smfmac_f32_16x16x64_bf16 v[204:207], v[16:19], a[192:199], v251
    v_smfmac_f32_16x16x64_bf16 v[204:207], v[44:47], a[0:7], v251
    v_smfmac_f32_16x16x64_bf16 v[204:207], v[48:51], a[40:47], v251
    s_mov_b32 exec_hi, 0
    ds_write_b128 v239, v[192:195] offset:4096
    s_mov_b32 exec_hi, -1
    v_smfmac_f32_16x16x64_bf16 v[208:211], v[16:19], a[224:231], v251
    v_smfmac_f32_16x16x64_bf16 v[208:211], v[44:47], a[8:15], v251
    v_smfmac_f32_16x16x64_bf16 v[208:211], v[48:51], a[48:55], v251
    s_mov_b32 exec_hi, 0
    ds_write_b128 v239, v[196:199] offset:4608
    s_mov_b32 exec_hi, -1
    s_mov_b32 exec_hi, 0
    ds_write_b128 v239, v[200:203] offset:5120
    ds_write_b128 v239, v[204:207] offset:5632
    s_nop 3
    ds_write_b128 v239, v[208:211] offset:6144
    s_mov_b64 exec, -1
    s_waitcnt lgkmcnt(0)
    s_barrier
    ds_read_b128 v[84:87], v234 offset:4096
    ds_read_b128 v[88:91], v234 offset:6656
    ds_read_b128 v[92:95], v234 offset:9216
    ds_read_b128 v[96:99], v234 offset:11776
    s_waitcnt lgkmcnt(2)
    v_pk_add_f32 v[84:85], v[84:85], v[88:89]
    v_pk_add_f32 v[86:87], v[86:87], v[90:91]
    s_waitcnt lgkmcnt(0)
    v_pk_add_f32 v[92:93], v[92:93], v[96:97]
    v_pk_add_f32 v[94:95], v[94:95], v[98:99]
    v_pk_add_f32 v[84:85], v[84:85], v[92:93]
    v_pk_add_f32 v[86:87], v[86:87], v[94:95]
    s_cmp_eq_u32 s28, 0
    v_cvt_pk_bf16_f32 v64, v84, v85
    v_cvt_pk_bf16_f32 v65, v86, v87
    s_cbranch_scc1 L_ys_far
    buffer_store_dwordx2 v[64:65], v236, s[80:83], 0 offen
L_ys_done:
    s_cmp_eq_u32 s15, 0
    s_cbranch_scc1 L_fin
    s_cmp_eq_u32 s15, 3
    s_cbranch_scc1 L_noe
    s_barrier
    buffer_load_dwordx4 a[68:71], v240, s[60:63], s6 offen
    s_add_u32 s6, s6, s69
    buffer_load_dwordx4 a[72:75], v240, s[60:63], s6 offen
    buffer_load_dwordx4 a[76:79], v240, s[64:67], s4 offen
    s_add_u32 s4, s4, s68
    buffer_load_dwordx4 a[80:83], v240, s[64:67], s4 offen
    s_add_u32 s4, s4, s68
    buffer_load_dwordx4 a[84:87], v240, s[64:67], s4 offen
    s_add_u32 s4, s4, s68
    buffer_load_dwordx4 a[88:91], v240, s[64:67], s4 offen
    s_add_u32 s4, s4, s69
    buffer_load_dwordx4 a[92:95], v240, s[64:67], s4 offen
L_noe:
    s_mov_b32 s92, 1048576
    s_mov_b32 s94, 0
    s_cmp_eq_u32 s15, 1
    s_cbranch_scc1 L_f1
    s_cmp_eq_u32 s15, 2
    s_cbranch_scc1 L_f2
    s_add_u32 s40, s22, 16384
    s_add_u32 s41, s22, 32768
    s_add_u32 s42, s23, 32768
    s_add_u32 s43, s23, 65536
    s_cmp_lt_u32 s3, 2
    s_cselect_b32 s41, s41, 2147479536
    s_cselect_b32 s43, s43, 2147479536
    v_lshlrev_b32 v46, 4, v2
    v_lshl_add_u32 v46, v3, 3, v46
L_c_lp:
    buffer_load_dwordx4 v[68:71], v5, s[80:83], s22 offen sc1
    buffer_load_dwordx4 v[72:75], v5, s[80:83], s40 offen sc1
    buffer_load_dwordx4 v[76:79], v5, s[80:83], s41 offen sc1
L_c_mm:
    s_waitcnt vmcnt(2)
    v_mfma_f32_16x16x32_bf16 v[176:179], v[224:227], v[68:71], 0
    s_waitcnt vmcnt(1)
    v_mfma_f32_16x16x32_bf16 v[180:183], v[224:227], v[72:75], 0
    s_waitcnt vmcnt(0)
    v_mfma_f32_16x16x32_bf16 v[184:187], v[224:227], v[76:79], 0
    s_sub_u32 s92, s92, 1
    s_and_b32 s93, s92, 63
    s_nop 3
    v_add_f32 v40, v176, v180
    v_cvt_pk_bf16_f32 v176, v176, v177
    v_cmp_u_f32 vcc, v40, v184
    v_cvt_pk_bf16_f32 v177, v178, v179
    v_cvt_pk_bf16_f32 v180, v180, v181
    v_cvt_pk_bf16_f32 v181, v182, v183
    v_cvt_pk_bf16_f32 v184, v184, v185
    v_cvt_pk_bf16_f32 v185, v186, v187
    s_cbranch_vccz L_c_ok
    s_cbranch_scc1 L_c_lp
    s_waitcnt vmcnt(0)
    s_cmp_eq_u32 s94, 1
    s_cbranch_scc1 L_c_ok
    v_max3_u32 v40, v68, v69, v70
    v_max3_u32 v40, v40, v71, v72
    v_max3_u32 v40, v40, v73, v74
    v_max3_u32 v40, v40, v75, v76
    v_max3_u32 v40, v40, v77, v78
    v_max_u32 v40, v40, v79
    v_cmp_eq_u32 vcc, -1, v40
    s_cmp_eq_u32 s92, 0
    s_cbranch_scc1 L_c_ok
    s_cbranch_vccnz L_c_lp
    s_mov_b32 s94, 1
    s_add_u32 s92, s92, 1
    s_branch L_c_mm
L_c_ok:
    s_mov_b32 exec_hi, 0
    buffer_store_dwordx2 v[176:177], v46, s[80:83], s23 offen sc1
    buffer_store_dwordx2 v[180:181], v46, s[80:83], s42 offen sc1
    buffer_store_dwordx2 v[184:185], v46, s[80:83], s43 offen sc1
    s_mov_b64 exec, -1
    s_branch L_fin
L_ys_far:
    buffer_store_dwordx2 v[64:65], v236, s[80:83], 0 offen sc1
    s_branch L_ys_done
L_f1:
    s_mov_b64 s[40:41], -1
    s_mov_b64 s[42:43], -1
    v_mov_b32 v160, 0x3f803f80
    v_mov_b32 v161, 0x3f803f80
    v_mov_b32 v162, 0x3f803f80
    v_mov_b32 v163, 0x3f803f80
    v_mov_b32 v164, 0x3f803f80
    v_mov_b32 v165, 0x3f803f80
    v_mov_b32 v166, 0x3f803f80
    v_mov_b32 v167, 0x3f803f80
    s_waitcnt vmcnt(10)
    ds_write_b128 v241, a[56:59] offset:16384
    s_waitcnt vmcnt(9)
    ds_write_b128 v241, a[60:63] offset:17472
    s_waitcnt vmcnt(8)
    ds_write_b128 v241, a[64:67] offset:18560
    s_waitcnt vmcnt(6)
    ds_write_b128 v241, a[68:71] offset:19648
    s_waitcnt vmcnt(4)
    ds_write_b128 v241, a[76:79] offset:21824
    s_waitcnt vmcnt(3)
    ds_write_b128 v241, a[80:83] offset:22912
    s_waitcnt vmcnt(2)
    ds_write_b128 v241, a[84:87] offset:24000
    s_waitcnt vmcnt(1)
    ds_write_b128 v241, a[88:91] offset:25088
    s_waitcnt lgkmcnt(0)
    s_barrier
    ds_read_b64_tr_b16 v[128:129], v245 offset:16384
    ds_read_b64_tr_b16 v[130:131], v245 offset:17472
    ds_read_b64_tr_b16 v[132:133], v245 offset:38144
    ds_read_b64_tr_b16 v[134:135], v245 offset:39232
    ds_read_b64_tr_b16 v[136:137], v245 offset:21824
    ds_read_b64_tr_b16 v[138:139], v245 offset:22912
    ds_read_b64_tr_b16 v[140:141], v245 offset:43584
    ds_read_b64_tr_b16 v[142:143], v245 offset:44672
    s_waitcnt lgkmcnt(4)
    ds_read_b64_tr_b16 v[144:145], v245 offset:16416
    ds_read_b64_tr_b16 v[146:147], v245 offset:17504
    ds_read_b64_tr_b16 v[148:149], v245 offset:38176
    ds_read_b64_tr_b16 v[150:151], v245 offset:39264
    ds_read_b64_tr_b16 v[152:153], v245 offset:21856
    ds_read_b64_tr_b16 v[154:155], v245 offset:22944
    ds_read_b64_tr_b16 v[156:157], v245 offset:43616
    ds_read_b64_tr_b16 v[158:159], v245 offset:44704
    s_or_b64 exec, s[40:41], 1
    buffer_load_dwordx4 v[68:71], v5, s[80:83], s24 offen offset:0 sc1
    s_or_b64 exec, s[42:43], 1
    buffer_load_dwordx4 v[72:75], v5, s[80:83], s24 offen offset:1024 sc1
    s_mov_b64 exec, -1
    s_waitcnt lgkmcnt(0)
    s_branch L_f1_mm
L_y_lp:
    s_or_b64 exec, s[40:41], 1
    buffer_load_dwordx4 v[68:71], v5, s[80:83], s24 offen offset:0 sc1
    s_or_b64 exec, s[42:43], 1
    buffer_load_dwordx4 v[72:75], v5, s[80:83], s24 offen offset:1024 sc1
    s_mov_b64 exec, -1
L_y_mm:
    s_waitcnt vmcnt(1)
    v_mfma_f32_16x16x32_bf16 v[196:199], v[224:227], v[68:71], 0
    v_cmp_eq_u32 s[40:41], -1, v68
    s_waitcnt vmcnt(0)
    v_mfma_f32_16x16x32_bf16 v[196:199], v[224:227], v[72:75], v[196:199]
    v_cmp_eq_u32 s[42:43], -1, v72
L_y_chk:
    s_sub_u32 s92, s92, 1
    s_and_b32 s93, s92, 63
    s_nop 4
    v_cmp_u_f32 vcc, v196, v196
    v_add_f32_dpp v196, v196, v196 row_ror:8 row_mask:0xf bank_mask:0xf
    v_add_f32_dpp v197, v197, v197 row_ror:8 row_mask:0xf bank_mask:0xf
    v_add_f32_dpp v198, v198, v198 row_ror:8 row_mask:0xf bank_mask:0xf
    v_add_f32_dpp v199, v199, v199 row_ror:8 row_mask:0xf bank_mask:0xf
    s_cbranch_vccz L_y_ok
    s_cbranch_scc1 L_y_lp
    s_waitcnt vmcnt(0)
    s_cmp_eq_u32 s94, 1
    s_cbranch_scc1 L_y_ok
    s_mov_b64 s[40:41], -1
    s_mov_b64 s[42:43], -1
    v_max3_u32 v40, v68, v69, v70
    v_max3_u32 v40, v40, v71, v72
    v_max3_u32 v40, v40, v73, v74
    v_max_u32 v40, v40, v75
    v_cmp_eq_u32 vcc, -1, v40
    s_cmp_eq_u32 s92, 0
    s_cbranch_scc1 L_y_ok
    s_cbranch_vccnz L_y_lp
    s_mov_b32 s94, 1
    s_add_u32 s92, s92, 1
    s_branch L_y_mm
L_y_ok:
    v_cvt_pk_bf16_f32 v40, v196, v197
    v_cvt_pk_bf16_f32 v41, v198, v199
    v_lshlrev_b32 v42, 16, v40
    v_and_b32 v43, 0xffff0000, v40
    v_lshlrev_b32 v44, 16, v41
    v_and_b32 v45, 0xffff0000, v41
    v_pk_add_f32 v[42:43], v[42:43], v[228:229]
    v_pk_add_f32 v[44:45], v[44:45], v[230:231]
    v_cvt_pk_bf16_f32 v40, v42, v43
    v_cvt_pk_bf16_f32 v41, v44, v45
    s_mov_b32 exec_hi, 0
    ds_write_b64 v246, v[40:41] offset:14336
    s_mov_b64 exec, -1
    v_lshlrev_b32 v228, 16, v40
    v_and_b32 v229, 0xffff0000, v40
    v_lshlrev_b32 v230, 16, v41
    v_and_b32 v231, 0xffff0000, v41
    s_waitcnt lgkmcnt(0)
    s_barrier
    ds_read_b128 v[160:163], v247 offset:14336
    ds_read_b128 v[164:167], v247 offset:14400
    s_waitcnt lgkmcnt(1)
    v_mfma_f32_16x16x32_bf16 v[192:195], v[160:163], v[160:163], 0
    s_waitcnt lgkmcnt(0)
    v_mfma_f32_16x16x32_bf16 v[192:195], v[164:167], v[164:167], v[192:195]
L_f1_mm:
    v_mfma_f32_16x16x32_bf16 v[176:179], v[128:131], v[160:163], 0
    v_mfma_f32_16x16x32_bf16 v[176:179], v[132:135], v[164:167], v[176:179]
    v_mfma_f32_16x16x32_bf16 v[180:183], v[136:139], v[160:163], 0
    v_mfma_f32_16x16x32_bf16 v[180:183], v[140:143], v[164:167], v[180:183]
    v_mfma_f32_16x16x32_bf16 v[184:187], v[144:147], v[160:163], 0
    v_mfma_f32_16x16x32_bf16 v[184:187], v[148:151], v[164:167], v[184:187]
    v_mfma_f32_16x16x32_bf16 v[188:191], v[152:155], v[160:163], 0
    v_mfma_f32_16x16x32_bf16 v[188:191], v[156:159], v[164:167], v[188:191]
    s_cmp_lg_u32 s70, 1
    s_cbranch_scc1 L_f1_other
    s_mov_b64 exec, 0xff
    buffer_store_dwordx4 v[192:195], v5, s[80:83], s21 offen
    s_mov_b32 exec_lo, 0x000f000f
    s_mov_b32 exec_hi, 0x000f000f
    buffer_store_dwordx4 v[176:179], v248, s[80:83], s71 offen offset:0
    buffer_store_dwordx4 v[180:183], v248, s[80:83], s71 offen offset:256
    buffer_store_dwordx4 v[184:187], v248, s[80:83], s30 offen offset:0
    buffer_store_dwordx4 v[188:191], v248, s[80:83], s30 offen offset:256
    s_mov_b64 exec, -1
L_f1_done:
    s_mul_i32 s93, s3, 3
    s_cmp_lg_u32 s93, s14
    s_cbranch_scc1 L_fin
    s_mov_b32 s92, 1048576
    s_mov_b32 s94, 0
    v_mov_b32 v92, 0
    v_mov_b32 v93, 0
    v_mov_b32 v94, 0
    v_mov_b32 v95, 0
    s_mov_b64 s[40:41], -1
    s_mov_b64 s[42:43], -1
    s_mov_b64 s[44:45], -1
    s_mov_b64 s[46:47], -1
    s_mov_b64 s[48:49], -1
    s_mov_b64 s[50:51], -1
    s_mov_b64 s[52:53], -1
    s_mov_b32 s53, 0xffff
    s_and_b32 s93, s2, 7
    s_lshl_b32 s93, s93, 7
    s_add_u32 s95, s93, 532480
    v_lshlrev_b32 v46, 2, v1
    s_mov_b32 exec_hi, 0
L_fl_lp:
    buffer_load_dword v47, v46, s[80:83], s95 offen sc1
    s_sub_u32 s92, s92, 1
    s_waitcnt vmcnt(0)
    v_cmp_eq_u32 vcc, -1, v47
    s_cbranch_scc1 L_fl_ok
    s_cbranch_vccnz L_fl_lp
L_fl_ok:
    s_mov_b32 s92, 1048576
L_f_lp:
    s_or_b64 exec, s[40:41], 1
    buffer_load_dwordx4 v[68:71], v5, s[80:83], s26 offen offset:0 sc1
    s_or_b64 exec, s[42:43], 1
    buffer_load_dwordx4 v[72:75], v5, s[80:83], s26 offen offset:1024 sc1
    s_or_b64 exec, s[44:45], 1
    buffer_load_dwordx4 v[76:79], v5, s[80:83], s26 offen offset:2048 sc1
    s_or_b64 exec, s[46:47], 1
    buffer_load_dwordx4 v[80:83], v5, s[80:83], s26 offen offset:3072 sc1
    s_or_b64 exec, s[48:49], 1
    buffer_load_dwordx4 v[84:87], v5, s[80:83], s27 offen offset:0 sc1
    s_or_b64 exec, s[50:51], 1
    buffer_load_dwordx4 v[88:91], v5, s[80:83], s27 offen offset:1024 sc1
    s_or_b64 exec, s[52:53], 1
    buffer_load_dwordx4 v[92:95], v5, s[80:83], s27 offen offset:2048 sc1
    s_mov_b64 exec, -1
L_f_mm:
    s_waitcnt vmcnt(6)
    v_mfma_f32_16x16x32_bf16 v[196:199], v[224:227], v[68:71], 0
    v_cmp_eq_u32 s[40:41], -1, v68
    s_waitcnt vmcnt(5)
    v_mfma_f32_16x16x32_bf16 v[196:199], v[224:227], v[72:75], v[196:199]
    v_cmp_eq_u32 s[42:43], -1, v72
    s_waitcnt vmcnt(4)
    v_mfma_f32_16x16x32_bf16 v[196:199], v[224:227], v[76:79], v[196:199]
    v_cmp_eq_u32 s[44:45], -1, v76
    s_waitcnt vmcnt(3)
    v_mfma_f32_16x16x32_bf16 v[196:199], v[224:227], v[80:83], v[196:199]
    v_cmp_eq_u32 s[46:47], -1, v80
    s_waitcnt vmcnt(2)
    v_mfma_f32_16x16x32_bf16 v[196:199], v[224:227], v[84:87], v[196:199]
    v_cmp_eq_u32 s[48:49], -1, v84
    s_waitcnt vmcnt(1)
    v_mfma_f32_16x16x32_bf16 v[196:199], v[224:227], v[88:91], v[196:199]
    v_cmp_eq_u32 s[50:51], -1, v88
    s_waitcnt vmcnt(0)
    v_mfma_f32_16x16x32_bf16 v[196:199], v[224:227], v[92:95], v[196:199]
    v_cmp_eq_u32 s[52:53], -1, v92
L_f_chk:
    s_sub_u32 s92, s92, 1
    s_and_b32 s93, s92, 63
    s_nop 4
    v_cmp_u_f32 vcc, v196, v196
    v_add_f32_dpp v196, v196, v196 row_ror:8 row_mask:0xf bank_mask:0xf
    v_add_f32_dpp v197, v197, v197 row_ror:8 row_mask:0xf bank_mask:0xf
    v_add_f32_dpp v198, v198, v198 row_ror:8 row_mask:0xf bank_mask:0xf
    v_add_f32_dpp v199, v199, v199 row_ror:8 row_mask:0xf bank_mask:0xf
    s_cbranch_vccz L_f_ok
    s_cbranch_scc1 L_f_lp
    s_waitcnt vmcnt(0)
    s_cmp_eq_u32 s94, 1
    s_cbranch_scc1 L_f_ok
    s_mov_b64 s[40:41], -1
    s_mov_b64 s[42:43], -1
    s_mov_b64 s[44:45], -1
    s_mov_b64 s[46:47], -1
    s_mov_b64 s[48:49], -1
    s_mov_b64 s[50:51], -1
    s_mov_b64 s[52:53], -1
    s_mov_b32 s53, 0xffff
    v_max3_u32 v40, v68, v69, v70
    v_max3_u32 v40, v40, v71, v72
    v_max3_u32 v40, v40, v73, v74
    v_max3_u32 v40, v40, v75, v76
    v_max3_u32 v40, v40, v77, v78
    v_max3_u32 v40, v40, v79, v80
    v_max3_u32 v40, v40, v81, v82
    v_max3_u32 v40, v40, v83, v84
    v_max3_u32 v40, v40, v85, v86
    v_max3_u32 v40, v40, v87, v88
    v_max3_u32 v40, v40, v89, v90
    v_max3_u32 v40, v40, v91, v92
    v_max3_u32 v40, v40, v93, v94
    v_max_u32 v40, v40, v95
    v_cmp_eq_u32 vcc, -1, v40
    s_cmp_eq_u32 s92, 0
    s_cbranch_scc1 L_f_ok
    s_cbranch_vccnz L_f_lp
    s_mov_b32 s94, 1
    s_add_u32 s92, s92, 1
    s_branch L_f_mm
L_f_ok:
    v_cvt_pk_bf16_f32 v40, v196, v197
    v_cvt_pk_bf16_f32 v41, v198, v199
    v_lshlrev_b32 v42, 16, v40
    v_and_b32 v43, 0xffff0000, v40
    v_lshlrev_b32 v44, 16, v41
    v_and_b32 v45, 0xffff0000, v41
    v_pk_add_f32 v[42:43], v[42:43], v[228:229]
    v_pk_add_f32 v[44:45], v[44:45], v[230:231]
    v_cvt_pk_bf16_f32 v40, v42, v43
    v_cvt_pk_bf16_f32 v41, v44, v45
    s_mov_b32 exec_lo, 0x00ff00ff
    s_mov_b32 exec_hi, 0
    buffer_store_dwordx2 v[40:41], v237, s[72:75], s20 offen
    s_mov_b64 exec, -1
    s_branch L_fin
L_f1_other:
    s_cmp_eq_u32 s70, 0
    s_cbranch_scc1 L_f1_cs
    s_mov_b64 exec, 0xff
    buffer_store_dwordx4 v[192:195], v5, s[80:83], s21 offen sc1
    s_mov_b32 exec_lo, 0x000f000f
    s_mov_b32 exec_hi, 0x000f000f
    buffer_store_dwordx4 v[176:179], v248, s[80:83], s71 offen offset:0 sc1
    buffer_store_dwordx4 v[180:183], v248, s[80:83], s71 offen offset:256 sc1
    buffer_store_dwordx4 v[184:187], v248, s[80:83], s30 offen offset:0 sc1
    buffer_store_dwordx4 v[188:191], v248, s[80:83], s30 offen offset:256 sc1
    s_mov_b64 exec, -1
    s_branch L_f1_done
L_f1_cs:
    s_mov_b32 exec_lo, 0x00010001
    s_mov_b32 exec_hi, 0x00010001
    s_cmp_eq_u32 s28, 0
    s_cbranch_scc1 L_f1_csr
    buffer_store_dwordx4 v[176:179], v249, s[80:83], s29 offen offset:0
    buffer_store_dwordx4 v[180:183], v249, s[80:83], s29 offen offset:64
    buffer_store_dwordx4 v[184:187], v249, s[80:83], s29 offen offset:1280
    buffer_store_dwordx4 v[188:191], v249, s[80:83], s29 offen offset:1344
    s_branch L_f1_csd
L_f1_csr:
    buffer_store_dwordx4 v[176:179], v249, s[80:83], s29 offen offset:0 sc1
    buffer_store_dwordx4 v[180:183], v249, s[80:83], s29 offen offset:64 sc1
    buffer_store_dwordx4 v[184:187], v249, s[80:83], s29 offen offset:1280 sc1
    buffer_store_dwordx4 v[188:191], v249, s[80:83], s29 offen offset:1344 sc1
L_f1_csd:
    s_mov_b64 exec, -1
    s_sub_u32 s70, 2, s28
    s_waitcnt vmcnt(5)
    v_mfma_f32_16x16x32_bf16 v[196:199], v[224:227], v[68:71], 0
    v_cmp_eq_u32 s[40:41], -1, v68
    s_waitcnt vmcnt(4)
    v_mfma_f32_16x16x32_bf16 v[196:199], v[224:227], v[72:75], v[196:199]
    v_cmp_eq_u32 s[42:43], -1, v72
    s_branch L_y_chk
L_f2:
    s_mov_b32 s40, s25
    v_mul_u32_u24 v52, 20, v243
    v_add_u32 v52, v52, v3
    v_mul_u32_u24 v52, 272, v52
    v_lshl_add_u32 v52, v244, 3, v52
    s_lshr_b32 s94, s3, 1
    s_mul_i32 s94, s94, 832
    s_lshl_b32 s93, s3, 7
    s_add_u32 s94, s94, s93
    v_add_u32 v52, s94, v52
    v_mul_u32_u24 v60, 6912, v243
    v_lshl_add_u32 v60, v244, 5, v60
    v_lshl_add_u32 v60, v3, 3, v60
    s_mul_i32 s24, s3, 27648
    s_lshl_b32 s93, s12, 7
    s_add_u32 s24, s24, s93
    s_add_u32 s24, s24, 962560
    s_add_u32 s25, s24, 110592
    s_add_u32 s26, s24, 221184
    s_cmp_lt_u32 s3, 2
    s_cselect_b32 s26, s26, 2130706416
    v_lshl_add_u32 v55, v3, 2, v244
    v_cmp_gt_u32 vcc, 10, v55
    v_lshlrev_b32 v55, 7, v55
    v_lshl_add_u32 v56, v243, 2, v55
    v_mad_u32_u24 v55, v243, 20, v55
    v_mov_b32 v41, 2147483632
    v_cndmask_b32 v55, v41, v55, vcc
    v_cndmask_b32 v56, v41, v56, vcc
    s_lshr_b32 s93, s12, 2
    s_mul_i32 s21, s93, 1280
    s_add_u32 s21, s21, 534528
    s_mov_b32 s95, 2147479536
    s_lshl_b32 s27, s12, 4
    s_lshl_b32 s93, s3, 2
    s_add_u32 s27, s27, s93
    s_add_u32 s27, s27, 532480
    s_cmp_eq_u32 s28, 1
    s_cselect_b32 s42, s27, 2147479536
    s_cselect_b32 s43, 2147479536, s27
    v_mov_b32 v59, 0
    s_lshl_b32 s93, s12, 1
    s_add_u32 s93, s93, s3
    s_mul_i32 s71, s93, 5120
    s_lshr_b32 s16, s71, 2
    s_add_u32 s16, s16, 1239040
    s_add_u32 s17, s16, 256
    s_add_u32 s18, s16, 512
    s_add_u32 s19, s16, 768
    s_add_u32 s20, s16, 1024
    s_add_u32 s71, s71, 1382400
    v_lshlrev_b32 v58, 6, v3
    v_lshl_add_u32 v58, v244, 4, v58
    s_lshl_b32 s93, s3, 3
    v_add_u32 v57, s93, v5
    v_mov_b32 v112, 0
    v_mov_b32 v113, 0
    v_mov_b32 v114, 0
    v_mov_b32 v115, 0
    v_mov_b32 v116, 0
    v_mov_b32 v117, 0
    v_mov_b32 v118, 0
    v_mov_b32 v119, 0
    v_mov_b32 v120, 0
    v_mov_b32 v121, 0
    v_mov_b32 v122, 0
    v_mov_b32 v123, 0
    v_mov_b32 v124, 0
    v_mov_b32 v125, 0
    v_mov_b32 v126, 0
    v_mov_b32 v127, 0
    s_mov_b32 s94, 0
    s_cmp_gt_u32 s3, 1
    s_cbranch_scc1 L_f2_wait
    s_branch L_g_go
L_f2_pass:
    s_waitcnt vmcnt(10)
    ds_write_b128 v241, a[56:59] offset:16384
    s_waitcnt vmcnt(9)
    ds_write_b128 v241, a[60:63] offset:17472
    s_waitcnt vmcnt(8)
    ds_write_b128 v241, a[64:67] offset:18560
    s_waitcnt vmcnt(6)
    ds_write_b128 v241, a[68:71] offset:19648
    s_waitcnt vmcnt(5)
    ds_write_b128 v241, a[72:75] offset:20736
    s_waitcnt vmcnt(4)
    ds_write_b128 v241, a[76:79] offset:21824
    s_waitcnt vmcnt(3)
    ds_write_b128 v241, a[80:83] offset:22912
    s_waitcnt vmcnt(2)
    ds_write_b128 v241, a[84:87] offset:24000
    s_waitcnt vmcnt(1)
    ds_write_b128 v241, a[88:91] offset:25088
    s_waitcnt vmcnt(0)
    ds_write_b128 v241, a[92:95] offset:26176
    s_waitcnt lgkmcnt(0)
    s_barrier
    ds_read_b64_tr_b16 v[128:129], v52 offset:16384
    ds_read_b64_tr_b16 v[130:131], v52 offset:38144
    ds_read_b64_tr_b16 v[132:133], v52 offset:16416
    ds_read_b64_tr_b16 v[134:135], v52 offset:38176
    ds_read_b64_tr_b16 v[136:137], v52 offset:16448
    ds_read_b64_tr_b16 v[138:139], v52 offset:38208
    ds_read_b64_tr_b16 v[140:141], v52 offset:16480
    ds_read_b64_tr_b16 v[142:143], v52 offset:38240
    s_waitcnt lgkmcnt(4)
    ds_read_b64_tr_b16 v[144:145], v52 offset:18560
    ds_read_b64_tr_b16 v[146:147], v52 offset:40320
    ds_read_b64_tr_b16 v[148:149], v52 offset:18592
    ds_read_b64_tr_b16 v[150:151], v52 offset:40352
    ds_read_b64_tr_b16 v[152:153], v52 offset:18624
    ds_read_b64_tr_b16 v[154:155], v52 offset:40384
    ds_read_b64_tr_b16 v[156:157], v52 offset:18656
    ds_read_b64_tr_b16 v[158:159], v52 offset:40416
    s_waitcnt lgkmcnt(4)
    ds_read_b64_tr_b16 v[160:161], v52 offset:20736
    ds_read_b64_tr_b16 v[162:163], v52 offset:42496
    ds_read_b64_tr_b16 v[164:165], v52 offset:20768
    ds_read_b64_tr_b16 v[166:167], v52 offset:42528
    ds_read_b64_tr_b16 v[168:169], v52 offset:20800
    ds_read_b64_tr_b16 v[170:171], v52 offset:42560
    ds_read_b64_tr_b16 v[172:173], v52 offset:20832
    ds_read_b64_tr_b16 v[174:175], v52 offset:42592
    s_waitcnt lgkmcnt(4)
    s_cmp_gt_u32 s3, 1
    s_cbranch_scc1 L_f2_wait
L_g_lp:
    buffer_load_dword v102, v56, s[80:83], s95 offen offset:64 sc1
    buffer_load_dword v103, v55, s[80:83], s95 offen sc1
    buffer_load_dwordx4 v[68:71], v58, s[80:83], s16 offen sc1
    buffer_load_dwordx4 v[72:75], v58, s[80:83], s17 offen sc1
    buffer_load_dwordx4 v[76:79], v58, s[80:83], s18 offen sc1
    buffer_load_dwordx4 v[80:83], v58, s[80:83], s19 offen sc1
    buffer_load_dwordx4 v[84:87], v58, s[80:83], s20 offen sc1
L_g_mm:
    s_waitcnt vmcnt(5)
    v_add_f32_dpp v98, v102, v102 quad_perm:[1,0,3,2] row_mask:0xf bank_mask:0xf
    v_add_f32_dpp v99, v103, v103 quad_perm:[1,0,3,2] row_mask:0xf bank_mask:0xf
    s_waitcnt vmcnt(3)
    v_add_f32_dpp v98, v98, v98 quad_perm:[2,3,0,1] row_mask:0xf bank_mask:0xf
    v_add_f32_dpp v99, v99, v99 quad_perm:[2,3,0,1] row_mask:0xf bank_mask:0xf
    v_pk_add_f32 v[104:105], v[68:69], v[72:73]
    v_pk_add_f32 v[106:107], v[70:71], v[74:75]
    v_permlane32_swap_b32 v98, v99
    s_waitcnt vmcnt(2)
    v_add_f32 v98, v98, v99
    v_mov_b32 v99, v98
    v_pk_add_f32 v[104:105], v[104:105], v[76:77]
    v_pk_add_f32 v[106:107], v[106:107], v[78:79]
    v_permlane16_swap_b32 v98, v99
    s_waitcnt vmcnt(1)
    v_add_f32 v98, v98, v99
    v_mul_f32 v98, 0x3acccccd, v98
    v_mov_b32 v99, v98
    v_pk_add_f32 v[104:105], v[104:105], v[80:81]
    v_pk_add_f32 v[106:107], v[106:107], v[82:83]
    v_permlane32_swap_b32 v98, v99
    s_waitcnt vmcnt(0)
    v_fma_f32 v108, -v98, v98, v99
    v_pk_add_f32 v[104:105], v[104:105], v[84:85]
    v_pk_add_f32 v[106:107], v[106:107], v[86:87]
    v_max_f32 v99, 0, v108
    v_cvt_pk_bf16_f32 v99, v99, v99
    v_permlane32_swap_b32 v104, v106
    v_permlane32_swap_b32 v105, v107
    v_and_b32 v99, 0xffff0000, v99
    v_pk_add_f32 v[96:97], v[104:105], v[106:107]
    v_add_f32 v99, 0x3727c5ac, v99
    v_cvt_pk_bf16_f32 v99, v99, v99
    v_permlane16_swap_b32 v96, v97
    v_and_b32 v99, 0xffff0000, v99
    v_sqrt_f32 v99, v99
    v_add_f32 v109, v96, v97
    v_cmp_u_f32 vcc, v109, v108
    v_cvt_pk_bf16_f32 v99, v99, v99
    v_cvt_pk_bf16_f32 v98, v98, v98
    v_and_b32 v99, 0xffff0000, v99
    v_and_b32 v98, 0xffff0000, v98
    v_rcp_f32 v99, v99
    s_cbranch_vccz L_g_ok
    s_sub_u32 s92, s92, 1
    s_and_b32 s93, s92, 63
    s_cbranch_scc1 L_g_lp
    s_waitcnt vmcnt(0)
    s_cmp_eq_u32 s94, 1
    s_cbranch_scc1 L_g_ok
    v_max3_u32 v40, v102, v103, v68
    v_max3_u32 v40, v40, v69, v70
    v_max3_u32 v40, v40, v71, v72
    v_max3_u32 v40, v40, v73, v74
    v_max3_u32 v40, v40, v75, v76
    v_max3_u32 v40, v40, v77, v78
    v_max3_u32 v40, v40, v79, v80
    v_max3_u32 v40, v40, v81, v82
    v_max3_u32 v40, v40, v83, v84
    v_max3_u32 v40, v40, v85, v86
    v_max_u32 v40, v40, v87
    v_cmp_eq_u32 vcc, -1, v40
    s_cmp_eq_u32 s92, 0
    s_cbranch_scc1 L_g_ok
    s_cbranch_vccnz L_g_lp
    s_mov_b32 s94, 1
    s_add_u32 s92, s92, 1
    s_branch L_g_mm
L_g_ok:
    s_cmp_eq_u32 s95, s21
    s_cbranch_scc0 L_g_cs
L_g_go:
    v_fma_f32 v104, -v98, v100, v96
    v_fma_f32 v105, -v98, v101, v97
    v_mul_f32 v104, v104, v99
    v_mul_f32 v105, v105, v99
    v_cvt_pk_bf16_f32 v104, v104, v104
    v_and_b32 v104, 0xffff0000, v104
    v_mul_f32 v106, 0xbfb8aa3b, v104
    v_exp_f32 v106, v106
    v_cvt_pk_bf16_f32 v105, v105, v105
    v_and_b32 v105, 0xffff0000, v105
    v_add_f32 v106, 1.0, v106
    v_rcp_f32 v106, v106
    s_nop 0
    v_mul_f32 v104, v104, v106
    v_cvt_pk_bf16_f32 v104, v104, v104
    v_and_b32 v104, 0xffff0000, v104
    v_mul_f32 v104, v104, v105
    v_cvt_pk_bf16_f32 v104, v104, v104
    v_and_b32 v104, v104, v235
    s_nop 1
    v_or_b32_dpp v104, v104, v104 quad_perm:[1,0,3,2] row_mask:0xf bank_mask:0xf
    s_nop 1
    v_mov_b32_dpp v106, v104 quad_perm:[0,0,0,0] row_mask:0xf bank_mask:0xf
    v_mov_b32_dpp v107, v104 quad_perm:[2,2,2,2] row_mask:0xf bank_mask:0xf
    ds_write_b64 v57, v[106:107] offset:14336
L_f2_wait:
    s_waitcnt lgkmcnt(0)
    s_barrier
    s_mov_b32 exec_lo, 0x11111111
    s_mov_b32 exec_hi, 0x11111111
    ds_read_b128 v[112:115], v5 offset:14336
    s_mov_b32 exec_lo, 0x22222222
    s_mov_b32 exec_hi, 0x22222222
    ds_read_b128 v[116:119], v5 offset:14336
    s_mov_b32 exec_lo, 0x44444444
    s_mov_b32 exec_hi, 0x44444444
    ds_read_b128 v[120:123], v5 offset:14336
    s_mov_b32 exec_lo, 0x88888888
    s_mov_b32 exec_hi, 0x88888888
    ds_read_b128 v[124:127], v5 offset:14336
    s_mov_b64 exec, -1
    s_waitcnt lgkmcnt(3)
    v_mfma_f32_16x16x32_bf16 v[176:179], v[128:131], v[112:115], 0
    v_mfma_f32_16x16x32_bf16 v[180:183], v[144:147], v[112:115], 0
    v_mfma_f32_16x16x32_bf16 v[184:187], v[160:163], v[112:115], 0
    s_waitcnt lgkmcnt(2)
    v_mfma_f32_16x16x32_bf16 v[176:179], v[132:135], v[116:119], v[176:179]
    v_mfma_f32_16x16x32_bf16 v[180:183], v[148:151], v[116:119], v[180:183]
    v_mfma_f32_16x16x32_bf16 v[184:187], v[164:167], v[116:119], v[184:187]
    s_waitcnt lgkmcnt(1)
    v_mfma_f32_16x16x32_bf16 v[176:179], v[136:139], v[120:123], v[176:179]
    v_mfma_f32_16x16x32_bf16 v[180:183], v[152:155], v[120:123], v[180:183]
    v_mfma_f32_16x16x32_bf16 v[184:187], v[168:171], v[120:123], v[184:187]
    s_waitcnt lgkmcnt(0)
    v_mfma_f32_16x16x32_bf16 v[176:179], v[140:143], v[124:127], v[176:179]
    v_mfma_f32_16x16x32_bf16 v[180:183], v[156:159], v[124:127], v[180:183]
    v_mfma_f32_16x16x32_bf16 v[184:187], v[172:175], v[124:127], v[184:187]
    s_cmp_eq_u32 s70, 0
    s_cbranch_scc1 L_f2_next
    s_nop 3
    v_cvt_pk_bf16_f32 v176, v176, v177
    v_cvt_pk_bf16_f32 v177, v178, v179
    buffer_store_dwordx2 v[176:177], v60, s[80:83], s24 offen sc1
    v_cvt_pk_bf16_f32 v180, v180, v181
    v_cvt_pk_bf16_f32 v181, v182, v183
    buffer_store_dwordx2 v[180:181], v60, s[80:83], s25 offen sc1
    v_cvt_pk_bf16_f32 v184, v184, v185
    v_cvt_pk_bf16_f32 v185, v186, v187
    buffer_store_dwordx2 v[184:185], v60, s[80:83], s26 offen sc1
    s_mov_b64 exec, 1
    buffer_store_dword v59, v59, s[80:83], s42 offen
    buffer_store_dword v59, v59, s[80:83], s43 offen sc1
    s_mov_b64 exec, -1
    s_branch L_fin
L_f2_next:
    s_mov_b32 s70, 1
    s_branch L_f2_pass
L_g_cs:
    v_mov_b32 v100, v96
    v_mov_b32 v101, v97
    s_add_u32 s16, s71, 0
    s_add_u32 s17, s71, 1024
    s_add_u32 s18, s71, 2048
    s_add_u32 s19, s71, 3072
    s_add_u32 s20, s71, 4096
    v_mov_b32 v58, v5
    s_mov_b32 s95, s21
    s_mov_b32 s94, 0
    s_branch L_g_lp
L_fin:
L_end:
    s_endpgm
.section .rodata,"a"
.p2align 6
.amdhsa_kernel sequential_preLN__sliding_block_cached__glu_gated_swiglu__decode_kernel
  .amdhsa_next_free_vgpr 512
  .amdhsa_next_free_sgpr 102
  .amdhsa_accum_offset 256
  .amdhsa_group_segment_fixed_size 0
  .amdhsa_kernarg_size 96
  .amdhsa_user_sgpr_count 2
  .amdhsa_user_sgpr_kernarg_segment_ptr 1
  .amdhsa_system_sgpr_workgroup_id_x 1
  .amdhsa_float_denorm_mode_32 3
.end_amdhsa_kernel
```
